```python
import torch

def _softmax(x, axis=-1):
    return torch.softmax(x, dim=axis)

def _gelu(x):
    return torch.nn.functional.gelu(x, approximate='tanh')

def _silu(x):
    return torch.nn.functional.silu(x)

def _sigmoid(x):
    return torch.sigmoid(x)

def _layernorm(x, axis=-1, eps=1e-05):
    m = x.mean(dim=axis, keepdim=True)
    v = x.var(dim=axis, keepdim=True, unbiased=False)
    return (x - m) / torch.sqrt(v + eps)

def _scatter_add(tgt, idx, src, axis=0):
    return tgt.clone().index_add_(axis, idx, src)

def _segment_sum(src, seg, n):
    out = torch.zeros((n,) + src.shape[1:], dtype=src.dtype)
    return out.index_add_(0, seg, src)

def _pad(x, pw):
    flat = tuple((v for pair in reversed(pw) for v in pair))
    return torch.nn.functional.pad(x, flat)
kernel_name = 'standalone__dilated_atrous__vision'

def setup_inputs():

    _w = lambda a: (lambda t: t.to(torch.bfloat16) if t.is_floating_point() else t)(torch.as_tensor(a))
    H = W = 512
    C = 96
    k = 3
    return {'x': _w((lambda *s: torch.randn(*s, dtype=torch.bfloat16) * 0.05)(1, H, W, C)), 'w': _w((lambda *s: torch.randn(*s, dtype=torch.bfloat16) * 0.05)(k, k, C, C) * (1.0 / (k * C ** 0.5)))}

def reference(x, w):
    B, H, W, C = x.shape
    k = 3
    rate = 2
    pad = (k - 1) * rate // 2
    xp = _pad(x, ((0, 0), (pad, pad), (pad, pad), (0, 0)))
    out = torch.zeros_like(x)
    for i in range(k):
        for j in range(k):
            tap = xp[:, i * rate:i * rate + H, j * rate:j * rate + W, :].clone()
            out = out + torch.einsum('bhwc,co->bhwo', tap, w[i, j])
    return out
```

```asm
; @launch grid=(256,1,1) block=(256,1,1) lds=163840
.amdgcn_target "amdgcn-amd-amdhsa--gfx950"
.text
.globl standalone__dilated_atrous__vision_kernel
.p2align 8
.type standalone__dilated_atrous__vision_kernel,@function
standalone__dilated_atrous__vision_kernel:
    s_cmp_lt_u32 s2, 0x100
    s_cbranch_scc0 L_end
    s_load_dwordx4 s[4:7], s[0:1], 0x0
    s_load_dwordx2 s[8:9], s[0:1], 0x10
    v_lshrrev_b32 v2, 6, v0
    v_and_b32 v1, 63, v0
    s_and_b32 s25, s2, 7
    s_lshr_b32 s34, s2, 3
    v_readfirstlane_b32 s24, v2
    s_and_b32 s35, s34, 1
    s_lshr_b32 s26, s34, 1
    s_lshl_b32 s25, s25, 6
    s_add_u32 s25, s25, s35
    s_lshl_b32 s26, s26, 5
    s_lshr_b32 s52, s24, 1
    s_sub_u32 s36, s26, 2
    s_mul_i32 s47, s36, 192
    s_add_u32 s34, s25, 65
    s_min_u32 s34, s34, 512
    s_mul_i32 s14, s34, 98304
    s_mov_b32 s15, 0x20000
    s_lshl_b32 s34, s52, 1
    s_add_u32 s34, s34, s25
    s_sub_u32 s34, s34, 2
    s_mul_i32 s27, s34, 98304
    s_add_u32 s35, s24, 1
    s_bitcmp1_b32 s35, 1
    s_cbranch_scc1 L_prod
    v_lshlrev_b32 v31, 4, v1
    s_mul_i32 s40, s52, 21504
    s_mul_i32 s41, s52, 33792
    s_add_u32 s41, s41, 3072
    s_add_u32 s42, s40, 18432
    s_mul_i32 s43, s52, 9216
    s_mul_i32 s46, s52, 7168
    s_add_u32 s58, s46, 14336
    s_mov_b32 s18, 165888
    s_mov_b32 s19, 0x20000
    s_waitcnt lgkmcnt(0)
    s_mov_b32 s16, s6
    s_and_b32 s17, s7, 0xffff
    s_add_u32 m0, s43, 0
    s_add_u32 s44, s40, 0
    buffer_load_dwordx4 v31, s[16:19], s44 offen offset:0 lds
    buffer_load_dwordx4 v31, s[16:19], s44 offen offset:1024 lds
    buffer_load_dwordx4 v31, s[16:19], s44 offen offset:2048 lds
    s_add_u32 m0, s43, 3072
    s_add_u32 s44, s41, 0
    buffer_load_dwordx4 v31, s[16:19], s44 offen offset:0 lds
    buffer_load_dwordx4 v31, s[16:19], s44 offen offset:1024 lds
    buffer_load_dwordx4 v31, s[16:19], s44 offen offset:2048 lds
    s_add_u32 m0, s43, 6144
    s_add_u32 s44, s42, 0
    buffer_load_dwordx4 v31, s[16:19], s44 offen offset:0 lds
    buffer_load_dwordx4 v31, s[16:19], s44 offen offset:1024 lds
    buffer_load_dwordx4 v31, s[16:19], s44 offen offset:2048 lds
    s_mov_b32 s12, s4
    s_and_b32 s13, s5, 0xffff
    s_add_u32 s27, s27, 786432
    v_mov_b32 v9, 0x40000000
    v_mul_u32_u24 v3, 2731, v1
    v_lshrrev_b32 v3, 16, v3
    v_mul_u32_u24 v4, 24, v3
    v_add_u32 v5, 7, v3
    v_sub_u32 v4, v1, v4
    v_lshrrev_b32 v5, 4, v5
    v_mul_u32_u24 v6, 9, v5
    v_sub_u32 v6, v3, v6
    v_lshl_add_u32 v7, v6, 1, v5
    v_lshlrev_b32 v6, 4, v6
    v_and_b32 v6, 32, v6
    v_lshlrev_b32 v4, 4, v4
    v_xor_b32 v4, v4, v6
    v_lshl_add_u32 v5, v7, 1, s36
    v_mul_u32_u24 v7, 384, v7
    v_cmp_gt_u32 vcc, 0x200, v5
    v_add3_u32 v4, v4, v7, s47
    s_nop 0
    v_cndmask_b32 v22, v9, v4, vcc
    v_add_u32 v2, 64, v1
    v_mul_u32_u24 v3, 2731, v2
    v_lshrrev_b32 v3, 16, v3
    v_mul_u32_u24 v4, 24, v3
    v_add_u32 v5, 7, v3
    v_sub_u32 v4, v2, v4
    v_lshrrev_b32 v5, 4, v5
    v_mul_u32_u24 v6, 9, v5
    v_sub_u32 v6, v3, v6
    v_lshl_add_u32 v7, v6, 1, v5
    v_lshlrev_b32 v6, 4, v6
    v_and_b32 v6, 32, v6
    v_lshlrev_b32 v4, 4, v4
    v_xor_b32 v4, v4, v6
    v_lshl_add_u32 v5, v7, 1, s36
    v_mul_u32_u24 v7, 384, v7
    v_cmp_gt_u32 vcc, 0x200, v5
    v_add3_u32 v4, v4, v7, s47
    v_subrev_u32 v4, 1024, v4
    s_nop 0
    v_cndmask_b32 v23, v9, v4, vcc
    v_add_u32 v2, 128, v1
    v_mul_u32_u24 v3, 2731, v2
    v_lshrrev_b32 v3, 16, v3
    v_mul_u32_u24 v4, 24, v3
    v_add_u32 v5, 7, v3
    v_sub_u32 v4, v2, v4
    v_lshrrev_b32 v5, 4, v5
    v_mul_u32_u24 v6, 9, v5
    v_sub_u32 v6, v3, v6
    v_lshl_add_u32 v7, v6, 1, v5
    v_lshlrev_b32 v6, 4, v6
    v_and_b32 v6, 32, v6
    v_lshlrev_b32 v4, 4, v4
    v_xor_b32 v4, v4, v6
    v_lshl_add_u32 v5, v7, 1, s36
    v_mul_u32_u24 v7, 384, v7
    v_cmp_gt_u32 vcc, 0x200, v5
    v_add3_u32 v4, v4, v7, s47
    v_subrev_u32 v4, 2048, v4
    s_nop 0
    v_cndmask_b32 v24, v9, v4, vcc
    v_add_u32 v2, 192, v1
    v_mul_u32_u24 v3, 2731, v2
    v_lshrrev_b32 v3, 16, v3
    v_mul_u32_u24 v4, 24, v3
    v_add_u32 v5, 7, v3
    v_sub_u32 v4, v2, v4
    v_lshrrev_b32 v5, 4, v5
    v_mul_u32_u24 v6, 9, v5
    v_sub_u32 v6, v3, v6
    v_lshl_add_u32 v7, v6, 1, v5
    v_lshlrev_b32 v6, 4, v6
    v_and_b32 v6, 32, v6
    v_lshlrev_b32 v4, 4, v4
    v_xor_b32 v4, v4, v6
    v_lshl_add_u32 v5, v7, 1, s36
    v_mul_u32_u24 v7, 384, v7
    v_cmp_gt_u32 vcc, 0x200, v5
    v_add3_u32 v4, v4, v7, s47
    s_nop 0
    v_cndmask_b32 v25, v9, v4, vcc
    v_add_u32 v2, 256, v1
    v_mul_u32_u24 v3, 2731, v2
    v_lshrrev_b32 v3, 16, v3
    v_mul_u32_u24 v4, 24, v3
    v_add_u32 v5, 7, v3
    v_sub_u32 v4, v2, v4
    v_lshrrev_b32 v5, 4, v5
    v_mul_u32_u24 v6, 9, v5
    v_sub_u32 v6, v3, v6
    v_lshl_add_u32 v7, v6, 1, v5
    v_lshlrev_b32 v6, 4, v6
    v_and_b32 v6, 32, v6
    v_lshlrev_b32 v4, 4, v4
    v_xor_b32 v4, v4, v6
    v_lshl_add_u32 v5, v7, 1, s36
    v_mul_u32_u24 v7, 384, v7
    v_cmp_gt_u32 vcc, 0x200, v5
    v_add3_u32 v4, v4, v7, s47
    v_subrev_u32 v4, 1024, v4
    s_nop 0
    v_cndmask_b32 v26, v9, v4, vcc
    v_add_u32 v2, 320, v1
    v_mul_u32_u24 v3, 2731, v2
    v_lshrrev_b32 v3, 16, v3
    v_mul_u32_u24 v4, 24, v3
    v_add_u32 v5, 7, v3
    v_sub_u32 v4, v2, v4
    v_lshrrev_b32 v5, 4, v5
    v_mul_u32_u24 v6, 9, v5
    v_sub_u32 v6, v3, v6
    v_lshl_add_u32 v7, v6, 1, v5
    v_lshlrev_b32 v6, 4, v6
    v_and_b32 v6, 32, v6
    v_lshlrev_b32 v4, 4, v4
    v_xor_b32 v4, v4, v6
    v_lshl_add_u32 v5, v7, 1, s36
    v_mul_u32_u24 v7, 384, v7
    v_cmp_gt_u32 vcc, 0x200, v5
    v_add3_u32 v4, v4, v7, s47
    v_subrev_u32 v4, 2048, v4
    s_nop 0
    v_cndmask_b32 v27, v9, v4, vcc
    v_add_u32 v2, 384, v1
    v_mul_u32_u24 v3, 2731, v2
    v_lshrrev_b32 v3, 16, v3
    v_mul_u32_u24 v4, 24, v3
    v_add_u32 v5, 7, v3
    v_sub_u32 v4, v2, v4
    v_lshrrev_b32 v5, 4, v5
    v_mul_u32_u24 v6, 9, v5
    v_sub_u32 v6, v3, v6
    v_lshl_add_u32 v7, v6, 1, v5
    v_lshlrev_b32 v6, 4, v6
    v_and_b32 v6, 32, v6
    v_lshlrev_b32 v4, 4, v4
    v_xor_b32 v4, v4, v6
    v_lshl_add_u32 v5, v7, 1, s36
    v_mul_u32_u24 v7, 384, v7
    v_cmp_gt_u32 vcc, 0x200, v5
    v_add3_u32 v4, v4, v7, s47
    v_subrev_u32 v4, 3072, v4
    v_cmp_gt_u32 s[56:57], 48, v1
    s_nop 1
    s_and_b64 vcc, vcc, s[56:57]
    s_nop 0
    v_cndmask_b32 v28, v9, v4, vcc
    s_add_u32 m0, s43, 18432
    s_add_u32 s44, s40, 6144
    buffer_load_dwordx4 v31, s[16:19], s44 offen offset:0 lds
    buffer_load_dwordx4 v31, s[16:19], s44 offen offset:1024 lds
    buffer_load_dwordx4 v31, s[16:19], s44 offen offset:2048 lds
    s_add_u32 m0, s43, 21504
    s_add_u32 s44, s41, 6144
    buffer_load_dwordx4 v31, s[16:19], s44 offen offset:0 lds
    buffer_load_dwordx4 v31, s[16:19], s44 offen offset:1024 lds
    buffer_load_dwordx4 v31, s[16:19], s44 offen offset:2048 lds
    s_add_u32 m0, s43, 24576
    s_add_u32 s44, s42, 6144
    buffer_load_dwordx4 v31, s[16:19], s44 offen offset:0 lds
    buffer_load_dwordx4 v31, s[16:19], s44 offen offset:1024 lds
    buffer_load_dwordx4 v31, s[16:19], s44 offen offset:2048 lds
    s_add_u32 m0, s43, 36864
    s_add_u32 s44, s40, 12288
    buffer_load_dwordx4 v31, s[16:19], s44 offen offset:0 lds
    buffer_load_dwordx4 v31, s[16:19], s44 offen offset:1024 lds
    buffer_load_dwordx4 v31, s[16:19], s44 offen offset:2048 lds
    s_add_u32 m0, s43, 39936
    s_add_u32 s44, s41, 12288
    buffer_load_dwordx4 v31, s[16:19], s44 offen offset:0 lds
    buffer_load_dwordx4 v31, s[16:19], s44 offen offset:1024 lds
    buffer_load_dwordx4 v31, s[16:19], s44 offen offset:2048 lds
    s_add_u32 m0, s43, 43008
    s_add_u32 s44, s42, 12288
    buffer_load_dwordx4 v31, s[16:19], s44 offen offset:0 lds
    buffer_load_dwordx4 v31, s[16:19], s44 offen offset:1024 lds
    buffer_load_dwordx4 v31, s[16:19], s44 offen offset:2048 lds
    s_mov_b32 s20, s8
    s_and_b32 s21, s9, 0xffff
    s_mov_b32 s22, 50331648
    s_mov_b32 s23, 0x20000
    s_lshl_b32 s53, s52, 15
    s_or_b32 s53, s53, 0x3f80
    s_xor_b32 s54, s53, 0x8000
    s_lshl_b32 s45, s53, 16
    v_lshrrev_b32 v2, 3, v1
    v_lshrrev_b32 v3, 2, v1
    v_and_b32 v3, 1, v3
    v_mul_u32_u24 v3, 192, v3
    v_and_b32 v4, 3, v1
    v_lshl_add_u32 v3, v4, 3, v3
    s_cmp_lg_u32 s24, 0
    s_cselect_b32 s34, 3456, 0
    s_cmp_eq_u32 s24, 3
    s_cselect_b32 s35, 3456, 0
    v_mul_u32_u24 v4, 384, v2
    v_lshlrev_b32 v5, 4, v2
    v_and_b32 v5, 32, v5
    v_add3_u32 v4, v4, v3, s34
    v_add_u32 v14, v4, v5
    v_xor_b32 v5, 32, v5
    v_add_u32 v15, v4, v5
    v_add_u32 v10, 135168, v14
    v_add_u32 v11, 135168, v15
    v_add_u32 v2, 1, v2
    v_mul_u32_u24 v4, 384, v2
    v_lshlrev_b32 v5, 4, v2
    v_and_b32 v5, 32, v5
    v_add3_u32 v4, v4, v3, s35
    v_add_u32 v16, v4, v5
    v_xor_b32 v5, 32, v5
    v_add_u32 v17, v4, v5
    v_add_u32 v12, 135168, v16
    v_add_u32 v13, 135168, v17
    v_lshrrev_b32 v2, 2, v1
    v_mul_u32_u24 v2, 192, v2
    v_and_b32 v3, 3, v1
    v_lshlrev_b32 v3, 4, v3
    s_mul_i32 s34, s52, 12288
    v_add3_u32 v18, v2, v3, s34
    v_add_u32 v20, 55296, v18
    v_lshrrev_b32 v2, 4, v1
    v_bfe_u32 v3, v1, 2, 2
    v_cmp_eq_u32 vcc, v2, v3
    v_bfe_i32 v8, v1, 1, 1
    v_lshlrev_b32 v5, 4, v1
    v_cndmask_b32 v2, 0, -1, vcc
    v_and_b32 v5, 16, v5
    v_not_b32 v7, v8
    v_and_b32 v7, v7, v2
    v_and_b32 v8, v8, v2
    v_lshlrev_b32 v6, v5, s53
    v_and_b32 v36, v6, v7
    v_and_b32 v37, v6, v8
    v_lshlrev_b32 v6, v5, s54
    v_and_b32 v38, v6, v7
    v_and_b32 v39, v6, v8
    s_mov_b32 s31, 135168
    s_mov_b32 s32, 55296
    s_mov_b32 s33, 83968
    s_mov_b32 s55, 24576
    s_mov_b32 s30, 8
    v_lshlrev_b32 v29, 4, v1
    v_add_u32 v29, 0, v29
    v_and_b32 v2, 14, v1
    v_and_b32 v3, 1, v1
    v_lshlrev_b32 v2, 1, v2
    s_lshl_b32 s35, s52, 1
    s_add_u32 s35, s35, s26
    v_add_u32 v2, s35, v2
    v_mul_u32_u24 v2, 192, v2
    v_lshl_add_u32 v2, v3, 6, v2
    v_and_b32 v3, 48, v1
    v_add_u32 v30, v2, v3
    s_mov_b32 vcc_lo, 0x55555555
    s_mov_b32 vcc_hi, 0x55555555
    s_mul_i32 s28, s25, 98304
    s_mov_b32 s29, s28
    s_waitcnt vmcnt(18)
    s_barrier
    ds_read_b64_tr_b16 a[0:1], v18 offset:0
    ds_read_b64_tr_b16 a[2:3], v18 offset:3072
    ds_read_b64_tr_b16 a[4:5], v18 offset:8
    ds_read_b64_tr_b16 a[6:7], v18 offset:3080
    ds_read_b64_tr_b16 a[8:9], v18 offset:64
    ds_read_b64_tr_b16 a[10:11], v18 offset:3136
    ds_read_b64_tr_b16 a[12:13], v18 offset:72
    ds_read_b64_tr_b16 a[14:15], v18 offset:3144
    ds_read_b64_tr_b16 a[16:17], v18 offset:128
    ds_read_b64_tr_b16 a[18:19], v18 offset:3200
    ds_read_b64_tr_b16 a[20:21], v18 offset:136
    ds_read_b64_tr_b16 a[22:23], v18 offset:3208
    s_add_u32 m0, s43, 55296
    s_add_u32 s44, s40, 55296
    buffer_load_dwordx4 v31, s[16:19], s44 offen offset:0 lds
    buffer_load_dwordx4 v31, s[16:19], s44 offen offset:1024 lds
    buffer_load_dwordx4 v31, s[16:19], s44 offen offset:2048 lds
    s_add_u32 m0, s43, 58368
    s_add_u32 s44, s41, 55296
    buffer_load_dwordx4 v31, s[16:19], s44 offen offset:0 lds
    buffer_load_dwordx4 v31, s[16:19], s44 offen offset:1024 lds
    buffer_load_dwordx4 v31, s[16:19], s44 offen offset:2048 lds
    s_add_u32 m0, s43, 61440
    s_add_u32 s44, s42, 55296
    buffer_load_dwordx4 v31, s[16:19], s44 offen offset:0 lds
    buffer_load_dwordx4 v31, s[16:19], s44 offen offset:1024 lds
    buffer_load_dwordx4 v31, s[16:19], s44 offen offset:2048 lds
    s_waitcnt vmcnt(18) lgkmcnt(0)
    s_barrier
    ds_read_b64_tr_b16 a[24:25], v18 offset:18432
    ds_read_b64_tr_b16 a[26:27], v18 offset:21504
    ds_read_b64_tr_b16 a[28:29], v18 offset:18440
    ds_read_b64_tr_b16 a[30:31], v18 offset:21512
    ds_read_b64_tr_b16 a[32:33], v18 offset:18496
    ds_read_b64_tr_b16 a[34:35], v18 offset:21568
    ds_read_b64_tr_b16 a[36:37], v18 offset:18504
    ds_read_b64_tr_b16 a[38:39], v18 offset:21576
    ds_read_b64_tr_b16 a[40:41], v18 offset:18560
    ds_read_b64_tr_b16 a[42:43], v18 offset:21632
    ds_read_b64_tr_b16 a[44:45], v18 offset:18568
    ds_read_b64_tr_b16 a[46:47], v18 offset:21640
    s_add_u32 m0, s43, 73728
    s_add_u32 s44, s40, 61440
    buffer_load_dwordx4 v31, s[16:19], s44 offen offset:0 lds
    buffer_load_dwordx4 v31, s[16:19], s44 offen offset:1024 lds
    buffer_load_dwordx4 v31, s[16:19], s44 offen offset:2048 lds
    s_add_u32 m0, s43, 76800
    s_add_u32 s44, s41, 61440
    buffer_load_dwordx4 v31, s[16:19], s44 offen offset:0 lds
    buffer_load_dwordx4 v31, s[16:19], s44 offen offset:1024 lds
    buffer_load_dwordx4 v31, s[16:19], s44 offen offset:2048 lds
    s_add_u32 m0, s43, 79872
    s_add_u32 s44, s42, 61440
    buffer_load_dwordx4 v31, s[16:19], s44 offen offset:0 lds
    buffer_load_dwordx4 v31, s[16:19], s44 offen offset:1024 lds
    buffer_load_dwordx4 v31, s[16:19], s44 offen offset:2048 lds
    s_waitcnt vmcnt(18) lgkmcnt(0)
    s_barrier
    ds_read_b64_tr_b16 v[172:173], v10 offset:0
    ds_read_b64_tr_b16 v[174:175], v12 offset:0
    ds_read_b64_tr_b16 v[176:177], v11 offset:0
    ds_read_b64_tr_b16 v[178:179], v13 offset:0
    ds_read_b64_tr_b16 v[180:181], v10 offset:64
    ds_read_b64_tr_b16 v[182:183], v12 offset:64
    ds_read_b64_tr_b16 v[184:185], v11 offset:64
    ds_read_b64_tr_b16 v[186:187], v13 offset:64
    ds_read_b64_tr_b16 v[188:189], v10 offset:128
    ds_read_b64_tr_b16 v[190:191], v12 offset:128
    ds_read_b64_tr_b16 v[192:193], v11 offset:128
    ds_read_b64_tr_b16 v[194:195], v13 offset:128
    ds_read_b64_tr_b16 a[48:49], v18 offset:36864
    ds_read_b64_tr_b16 a[50:51], v18 offset:39936
    ds_read_b64_tr_b16 a[52:53], v18 offset:36872
    ds_read_b64_tr_b16 a[54:55], v18 offset:39944
    ds_read_b64_tr_b16 a[56:57], v18 offset:36928
    ds_read_b64_tr_b16 a[58:59], v18 offset:40000
    ds_read_b64_tr_b16 a[60:61], v18 offset:36936
    ds_read_b64_tr_b16 a[62:63], v18 offset:40008
    ds_read_b64_tr_b16 a[64:65], v18 offset:36992
    ds_read_b64_tr_b16 a[66:67], v18 offset:40064
    ds_read_b64_tr_b16 a[68:69], v18 offset:37000
    ds_read_b64_tr_b16 a[70:71], v18 offset:40072
    s_add_u32 m0, s43, 92160
    s_add_u32 s44, s40, 67584
    buffer_load_dwordx4 v31, s[16:19], s44 offen offset:0 lds
    buffer_load_dwordx4 v31, s[16:19], s44 offen offset:1024 lds
    buffer_load_dwordx4 v31, s[16:19], s44 offen offset:2048 lds
    s_waitcnt lgkmcnt(12)
    v_mfma_f32_16x16x32_bf16 v[196:199], v[172:175], v[36:39], 0
    v_mfma_f32_16x16x32_bf16 v[200:203], v[176:179], v[36:39], 0
    v_mfma_f32_16x16x32_bf16 v[204:207], v[180:183], v[36:39], 0
    v_mfma_f32_16x16x32_bf16 v[208:211], v[184:187], v[36:39], 0
    v_mfma_f32_16x16x32_bf16 v[212:215], v[188:191], v[36:39], 0
    v_mfma_f32_16x16x32_bf16 v[216:219], v[192:195], v[36:39], 0
    s_add_u32 m0, s43, 95232
    s_add_u32 s44, s41, 67584
    buffer_load_dwordx4 v31, s[16:19], s44 offen offset:0 lds
    buffer_load_dwordx4 v31, s[16:19], s44 offen offset:1024 lds
    buffer_load_dwordx4 v31, s[16:19], s44 offen offset:2048 lds
    s_nop 2
    v_cvt_pk_bf16_f32 v40, v196, v197
    v_cvt_pk_bf16_f32 v41, v198, v199
    v_cvt_pk_bf16_f32 v42, v200, v201
    v_cvt_pk_bf16_f32 v43, v202, v203
    v_cvt_pk_bf16_f32 v44, v204, v205
    v_cvt_pk_bf16_f32 v45, v206, v207
    s_add_u32 m0, s43, 98304
    s_add_u32 s44, s42, 67584
    buffer_load_dwordx4 v31, s[16:19], s44 offen offset:0 lds
    buffer_load_dwordx4 v31, s[16:19], s44 offen offset:1024 lds
    buffer_load_dwordx4 v31, s[16:19], s44 offen offset:2048 lds
    v_cvt_pk_bf16_f32 v46, v208, v209
    v_cvt_pk_bf16_f32 v47, v210, v211
    v_cvt_pk_bf16_f32 v48, v212, v213
    v_cvt_pk_bf16_f32 v49, v214, v215
    v_cvt_pk_bf16_f32 v50, v216, v217
    v_cvt_pk_bf16_f32 v51, v218, v219
    s_waitcnt vmcnt(18) lgkmcnt(0)
    s_barrier
    ds_read_b64_tr_b16 v[172:173], v10 offset:7168
    ds_read_b64_tr_b16 v[174:175], v12 offset:7168
    ds_read_b64_tr_b16 v[176:177], v11 offset:7168
    ds_read_b64_tr_b16 v[178:179], v13 offset:7168
    ds_read_b64_tr_b16 v[180:181], v10 offset:7232
    ds_read_b64_tr_b16 v[182:183], v12 offset:7232
    ds_read_b64_tr_b16 v[184:185], v11 offset:7232
    ds_read_b64_tr_b16 v[186:187], v13 offset:7232
    ds_read_b64_tr_b16 v[188:189], v10 offset:7296
    ds_read_b64_tr_b16 v[190:191], v12 offset:7296
    ds_read_b64_tr_b16 v[192:193], v11 offset:7296
    ds_read_b64_tr_b16 v[194:195], v13 offset:7296
    ds_read_b64_tr_b16 a[72:73], v20 offset:0
    ds_read_b64_tr_b16 a[74:75], v20 offset:3072
    ds_read_b64_tr_b16 a[76:77], v20 offset:8
    ds_read_b64_tr_b16 a[78:79], v20 offset:3080
    ds_read_b64_tr_b16 a[80:81], v20 offset:64
    ds_read_b64_tr_b16 a[82:83], v20 offset:3136
    ds_read_b64_tr_b16 a[84:85], v20 offset:72
    ds_read_b64_tr_b16 a[86:87], v20 offset:3144
    ds_read_b64_tr_b16 a[88:89], v20 offset:128
    ds_read_b64_tr_b16 a[90:91], v20 offset:3200
    ds_read_b64_tr_b16 a[92:93], v20 offset:136
    ds_read_b64_tr_b16 a[94:95], v20 offset:3208
    s_add_u32 m0, s43, 0
    s_add_u32 s44, s40, 110592
    buffer_load_dwordx4 v31, s[16:19], s44 offen offset:0 lds
    buffer_load_dwordx4 v31, s[16:19], s44 offen offset:1024 lds
    buffer_load_dwordx4 v31, s[16:19], s44 offen offset:2048 lds
    s_waitcnt lgkmcnt(12)
    v_mfma_f32_16x16x32_bf16 v[196:199], v[172:175], v[36:39], 0
    v_mfma_f32_16x16x32_bf16 v[200:203], v[176:179], v[36:39], 0
    v_mfma_f32_16x16x32_bf16 v[204:207], v[180:183], v[36:39], 0
    v_mfma_f32_16x16x32_bf16 v[208:211], v[184:187], v[36:39], 0
    v_mfma_f32_16x16x32_bf16 v[212:215], v[188:191], v[36:39], 0
    v_mfma_f32_16x16x32_bf16 v[216:219], v[192:195], v[36:39], 0
    s_add_u32 m0, s43, 3072
    s_add_u32 s44, s41, 110592
    buffer_load_dwordx4 v31, s[16:19], s44 offen offset:0 lds
    buffer_load_dwordx4 v31, s[16:19], s44 offen offset:1024 lds
    buffer_load_dwordx4 v31, s[16:19], s44 offen offset:2048 lds
    s_nop 2
    v_cvt_pk_bf16_f32 v52, v196, v197
    v_cvt_pk_bf16_f32 v53, v198, v199
    v_cvt_pk_bf16_f32 v54, v200, v201
    v_cvt_pk_bf16_f32 v55, v202, v203
    v_cvt_pk_bf16_f32 v56, v204, v205
    v_cvt_pk_bf16_f32 v57, v206, v207
    s_add_u32 m0, s43, 6144
    s_add_u32 s44, s42, 110592
    buffer_load_dwordx4 v31, s[16:19], s44 offen offset:0 lds
    buffer_load_dwordx4 v31, s[16:19], s44 offen offset:1024 lds
    buffer_load_dwordx4 v31, s[16:19], s44 offen offset:2048 lds
    v_cvt_pk_bf16_f32 v58, v208, v209
    v_cvt_pk_bf16_f32 v59, v210, v211
    v_cvt_pk_bf16_f32 v60, v212, v213
    v_cvt_pk_bf16_f32 v61, v214, v215
    v_cvt_pk_bf16_f32 v62, v216, v217
    v_cvt_pk_bf16_f32 v63, v218, v219
    s_waitcnt vmcnt(18) lgkmcnt(0)
    s_barrier
    ds_read_b64_tr_b16 a[96:97], v20 offset:18432
    ds_read_b64_tr_b16 a[98:99], v20 offset:21504
    ds_read_b64_tr_b16 a[100:101], v20 offset:18440
    ds_read_b64_tr_b16 a[102:103], v20 offset:21512
    ds_read_b64_tr_b16 a[104:105], v20 offset:18496
    ds_read_b64_tr_b16 a[106:107], v20 offset:21568
    ds_read_b64_tr_b16 a[108:109], v20 offset:18504
    ds_read_b64_tr_b16 a[110:111], v20 offset:21576
    ds_read_b64_tr_b16 a[112:113], v20 offset:18560
    ds_read_b64_tr_b16 a[114:115], v20 offset:21632
    ds_read_b64_tr_b16 a[116:117], v20 offset:18568
    ds_read_b64_tr_b16 a[118:119], v20 offset:21640
    s_add_u32 m0, s43, 18432
    s_add_u32 s44, s40, 116736
    buffer_load_dwordx4 v31, s[16:19], s44 offen offset:0 lds
    buffer_load_dwordx4 v31, s[16:19], s44 offen offset:1024 lds
    buffer_load_dwordx4 v31, s[16:19], s44 offen offset:2048 lds
    s_add_u32 m0, s43, 21504
    s_add_u32 s44, s41, 116736
    buffer_load_dwordx4 v31, s[16:19], s44 offen offset:0 lds
    buffer_load_dwordx4 v31, s[16:19], s44 offen offset:1024 lds
    buffer_load_dwordx4 v31, s[16:19], s44 offen offset:2048 lds
    s_add_u32 m0, s43, 24576
    s_add_u32 s44, s42, 116736
    buffer_load_dwordx4 v31, s[16:19], s44 offen offset:0 lds
    buffer_load_dwordx4 v31, s[16:19], s44 offen offset:1024 lds
    buffer_load_dwordx4 v31, s[16:19], s44 offen offset:2048 lds
    s_waitcnt vmcnt(18) lgkmcnt(0)
    s_barrier
    ds_read_b64_tr_b16 v[172:173], v10 offset:14336
    ds_read_b64_tr_b16 v[174:175], v12 offset:14336
    ds_read_b64_tr_b16 v[176:177], v11 offset:14336
    ds_read_b64_tr_b16 v[178:179], v13 offset:14336
    ds_read_b64_tr_b16 v[180:181], v10 offset:14400
    ds_read_b64_tr_b16 v[182:183], v12 offset:14400
    ds_read_b64_tr_b16 v[184:185], v11 offset:14400
    ds_read_b64_tr_b16 v[186:187], v13 offset:14400
    ds_read_b64_tr_b16 v[188:189], v10 offset:14464
    ds_read_b64_tr_b16 v[190:191], v12 offset:14464
    ds_read_b64_tr_b16 v[192:193], v11 offset:14464
    ds_read_b64_tr_b16 v[194:195], v13 offset:14464
    ds_read_b64_tr_b16 a[120:121], v20 offset:36864
    ds_read_b64_tr_b16 a[122:123], v20 offset:39936
    ds_read_b64_tr_b16 a[124:125], v20 offset:36872
    ds_read_b64_tr_b16 a[126:127], v20 offset:39944
    ds_read_b64_tr_b16 a[128:129], v20 offset:36928
    ds_read_b64_tr_b16 a[130:131], v20 offset:40000
    ds_read_b64_tr_b16 a[132:133], v20 offset:36936
    ds_read_b64_tr_b16 a[134:135], v20 offset:40008
    ds_read_b64_tr_b16 a[136:137], v20 offset:36992
    ds_read_b64_tr_b16 a[138:139], v20 offset:40064
    ds_read_b64_tr_b16 a[140:141], v20 offset:37000
    ds_read_b64_tr_b16 a[142:143], v20 offset:40072
    s_add_u32 m0, s43, 36864
    s_add_u32 s44, s40, 122880
    buffer_load_dwordx4 v31, s[16:19], s44 offen offset:0 lds
    buffer_load_dwordx4 v31, s[16:19], s44 offen offset:1024 lds
    buffer_load_dwordx4 v31, s[16:19], s44 offen offset:2048 lds
    s_waitcnt lgkmcnt(12)
    v_mfma_f32_16x16x32_bf16 v[196:199], v[172:175], v[36:39], 0
    v_mfma_f32_16x16x32_bf16 v[200:203], v[176:179], v[36:39], 0
    v_mfma_f32_16x16x32_bf16 v[204:207], v[180:183], v[36:39], 0
    v_mfma_f32_16x16x32_bf16 v[208:211], v[184:187], v[36:39], 0
    v_mfma_f32_16x16x32_bf16 v[212:215], v[188:191], v[36:39], 0
    v_mfma_f32_16x16x32_bf16 v[216:219], v[192:195], v[36:39], 0
    s_add_u32 m0, s43, 39936
    s_add_u32 s44, s41, 122880
    buffer_load_dwordx4 v31, s[16:19], s44 offen offset:0 lds
    buffer_load_dwordx4 v31, s[16:19], s44 offen offset:1024 lds
    buffer_load_dwordx4 v31, s[16:19], s44 offen offset:2048 lds
    s_nop 2
    v_cvt_pk_bf16_f32 v64, v196, v197
    v_cvt_pk_bf16_f32 v65, v198, v199
    v_cvt_pk_bf16_f32 v66, v200, v201
    v_cvt_pk_bf16_f32 v67, v202, v203
    v_cvt_pk_bf16_f32 v68, v204, v205
    v_cvt_pk_bf16_f32 v69, v206, v207
    s_add_u32 m0, s43, 43008
    s_add_u32 s44, s42, 122880
    buffer_load_dwordx4 v31, s[16:19], s44 offen offset:0 lds
    buffer_load_dwordx4 v31, s[16:19], s44 offen offset:1024 lds
    buffer_load_dwordx4 v31, s[16:19], s44 offen offset:2048 lds
    v_cvt_pk_bf16_f32 v70, v208, v209
    v_cvt_pk_bf16_f32 v71, v210, v211
    v_cvt_pk_bf16_f32 v72, v212, v213
    v_cvt_pk_bf16_f32 v73, v214, v215
    v_cvt_pk_bf16_f32 v74, v216, v217
    v_cvt_pk_bf16_f32 v75, v218, v219
    s_add_u32 m0, s46, 55296
    s_nop 0
    buffer_load_dwordx4 v22, s[12:15], s27 offen offset:0 lds
    buffer_load_dwordx4 v23, s[12:15], s27 offen offset:1024 lds
    buffer_load_dwordx4 v24, s[12:15], s27 offen offset:2048 lds
    s_addk_i32 m0, 0xc00
    s_nop 0
    buffer_load_dwordx4 v25, s[12:15], s27 offen offset:0 lds
    buffer_load_dwordx4 v26, s[12:15], s27 offen offset:1024 lds
    buffer_load_dwordx4 v27, s[12:15], s27 offen offset:2048 lds
    buffer_load_dwordx4 v28, s[12:15], s27 offen offset:3072 lds
    s_add_u32 s27, s27, 393216
    s_waitcnt vmcnt(25) lgkmcnt(0)
    s_barrier
    ds_read_b64_tr_b16 a[144:145], v18 offset:0
    ds_read_b64_tr_b16 a[146:147], v18 offset:3072
    ds_read_b64_tr_b16 a[148:149], v18 offset:8
    ds_read_b64_tr_b16 a[150:151], v18 offset:3080
    ds_read_b64_tr_b16 a[152:153], v18 offset:64
    ds_read_b64_tr_b16 a[154:155], v18 offset:3136
    ds_read_b64_tr_b16 a[156:157], v18 offset:72
    ds_read_b64_tr_b16 a[158:159], v18 offset:3144
    ds_read_b64_tr_b16 a[160:161], v18 offset:128
    ds_read_b64_tr_b16 a[162:163], v18 offset:3200
    ds_read_b64_tr_b16 a[164:165], v18 offset:136
    ds_read_b64_tr_b16 a[166:167], v18 offset:3208
    s_waitcnt vmcnt(16) lgkmcnt(0)
    s_barrier
    ds_read_b64_tr_b16 a[168:169], v18 offset:18432
    ds_read_b64_tr_b16 a[170:171], v18 offset:21504
    ds_read_b64_tr_b16 a[172:173], v18 offset:18440
    ds_read_b64_tr_b16 a[174:175], v18 offset:21512
    ds_read_b64_tr_b16 a[176:177], v18 offset:18496
    ds_read_b64_tr_b16 a[178:179], v18 offset:21568
    ds_read_b64_tr_b16 a[180:181], v18 offset:18504
    ds_read_b64_tr_b16 a[182:183], v18 offset:21576
    ds_read_b64_tr_b16 a[184:185], v18 offset:18560
    ds_read_b64_tr_b16 a[186:187], v18 offset:21632
    ds_read_b64_tr_b16 a[188:189], v18 offset:18568
    ds_read_b64_tr_b16 a[190:191], v18 offset:21640
    s_waitcnt vmcnt(7) lgkmcnt(0)
    s_barrier
    ds_read_b64_tr_b16 a[192:193], v18 offset:36864
    ds_read_b64_tr_b16 a[194:195], v18 offset:39936
    ds_read_b64_tr_b16 a[196:197], v18 offset:36872
    ds_read_b64_tr_b16 a[198:199], v18 offset:39944
    ds_read_b64_tr_b16 a[200:201], v18 offset:36928
    ds_read_b64_tr_b16 a[202:203], v18 offset:40000
    ds_read_b64_tr_b16 a[204:205], v18 offset:36936
    ds_read_b64_tr_b16 a[206:207], v18 offset:40008
    ds_read_b64_tr_b16 a[208:209], v18 offset:36992
    ds_read_b64_tr_b16 a[210:211], v18 offset:40064
    ds_read_b64_tr_b16 a[212:213], v18 offset:37000
    ds_read_b64_tr_b16 a[214:215], v18 offset:40072
    s_add_u32 m0, s46, 69632
    s_nop 0
    buffer_load_dwordx4 v22, s[12:15], s27 offen offset:0 lds
    buffer_load_dwordx4 v23, s[12:15], s27 offen offset:1024 lds
    buffer_load_dwordx4 v24, s[12:15], s27 offen offset:2048 lds
    s_addk_i32 m0, 0xc00
    s_nop 0
    buffer_load_dwordx4 v25, s[12:15], s27 offen offset:0 lds
    buffer_load_dwordx4 v26, s[12:15], s27 offen offset:1024 lds
    buffer_load_dwordx4 v27, s[12:15], s27 offen offset:2048 lds
    buffer_load_dwordx4 v28, s[12:15], s27 offen offset:3072 lds
    s_add_u32 s27, s27, 393216
    s_waitcnt vmcnt(7) lgkmcnt(0)
    s_barrier
    s_add_u32 m0, s46, 83968
    s_nop 0
    buffer_load_dwordx4 v22, s[12:15], s27 offen offset:0 lds
    buffer_load_dwordx4 v23, s[12:15], s27 offen offset:1024 lds
    buffer_load_dwordx4 v24, s[12:15], s27 offen offset:2048 lds
    s_addk_i32 m0, 0xc00
    s_nop 0
    buffer_load_dwordx4 v25, s[12:15], s27 offen offset:0 lds
    buffer_load_dwordx4 v26, s[12:15], s27 offen offset:1024 lds
    buffer_load_dwordx4 v27, s[12:15], s27 offen offset:2048 lds
    buffer_load_dwordx4 v28, s[12:15], s27 offen offset:3072 lds
    s_add_u32 s27, s27, 393216
    s_add_u32 m0, s46, 98304
    s_nop 0
    buffer_load_dwordx4 v22, s[12:15], s27 offen offset:0 lds
    buffer_load_dwordx4 v23, s[12:15], s27 offen offset:1024 lds
    buffer_load_dwordx4 v24, s[12:15], s27 offen offset:2048 lds
    s_addk_i32 m0, 0xc00
    s_nop 0
    buffer_load_dwordx4 v25, s[12:15], s27 offen offset:0 lds
    buffer_load_dwordx4 v26, s[12:15], s27 offen offset:1024 lds
    buffer_load_dwordx4 v27, s[12:15], s27 offen offset:2048 lds
    buffer_load_dwordx4 v28, s[12:15], s27 offen offset:3072 lds
    s_add_u32 s27, s27, 393216
    ds_read_b64_tr_b16 v[104:105], v10 offset:21504
    ds_read_b64_tr_b16 v[106:107], v12 offset:21504
    ds_read_b64_tr_b16 v[108:109], v11 offset:21504
    ds_read_b64_tr_b16 v[110:111], v13 offset:21504
    s_barrier
    ds_read_b128 v[116:119], v29 offset:0
    ds_read_b128 v[140:143], v29 offset:6144
    ds_read_b128 v[120:123], v29 offset:1024
    ds_read_b128 v[144:147], v29 offset:7168
    s_waitcnt lgkmcnt(2)
    v_fma_f32 v116, v140, s45, v116
    v_fma_f32 v117, v141, s45, v117
    v_fma_f32 v118, v142, s45, v118
    v_fma_f32 v119, v143, s45, v119
    .p2align 3
L_cloop:
    v_mfma_f32_16x16x32_bf16 v[88:91], v[104:107], v[36:39], 0
    ds_read_b64_tr_b16 v[112:113], v10 offset:21568
    v_cndmask_b32 v168, v152, v160, vcc
    v_mfma_f32_16x16x32_bf16 v[116:119], a[0:3], v[40:43], v[116:119]
    ds_read_b64_tr_b16 v[114:115], v12 offset:21568
    v_cndmask_b32 v169, v153, v161, vcc
    v_mfma_f32_16x16x32_bf16 v[116:119], a[24:27], v[44:47], v[116:119]
    ds_read_b128 v[124:127], v29 offset:2048
    s_add_u32 m0, s55, s46
    v_mfma_f32_16x16x32_bf16 v[116:119], a[48:51], v[48:51], v[116:119]
    ds_read_b128 v[148:151], v29 offset:8192
    v_mfma_f32_16x16x32_bf16 v[116:119], a[72:75], v[52:55], v[116:119]
    v_cvt_pk_bf16_f32 v162, v136, v137
    v_cvt_pk_bf16_f32 v163, v138, v139
    v_mfma_f32_16x16x32_bf16 v[116:119], a[96:99], v[56:59], v[116:119]
    v_cvt_pk_bf16_f32 v76, v88, v89
    v_cvt_pk_bf16_f32 v77, v90, v91
    v_mfma_f32_16x16x32_bf16 v[116:119], a[120:123], v[60:63], v[116:119]
    v_cndmask_b32 v170, v154, v162, vcc
    s_waitcnt lgkmcnt(4)
    v_mfma_f32_16x16x32_bf16 v[116:119], a[144:147], v[64:67], v[116:119]
    v_fmac_f32 v120, s45, v144
    v_fmac_f32 v121, s45, v145
    v_mfma_f32_16x16x32_bf16 v[116:119], a[168:171], v[68:71], v[116:119]
    v_fmac_f32 v122, s45, v146
    v_fmac_f32 v123, s45, v147
    v_mfma_f32_16x16x32_bf16 v[116:119], a[192:195], v[72:75], v[116:119]
    v_cndmask_b32 v171, v155, v163, vcc
    s_not_b64 vcc, vcc
    v_mfma_f32_16x16x32_bf16 v[92:95], v[108:111], v[36:39], 0
    ds_read_b64_tr_b16 v[104:105], v11 offset:21568
    v_cndmask_b32_dpp v160, v156, v160, vcc quad_perm:[1,0,3,2] row_mask:0xf bank_mask:0xf
    v_mfma_f32_16x16x32_bf16 v[120:123], a[4:7], v[40:43], v[120:123]
    ds_read_b64_tr_b16 v[106:107], v13 offset:21568
    v_cndmask_b32_dpp v161, v157, v161, vcc quad_perm:[1,0,3,2] row_mask:0xf bank_mask:0xf
    v_mfma_f32_16x16x32_bf16 v[120:123], a[28:31], v[44:47], v[120:123]
    ds_read_b128 v[128:131], v29 offset:3072
    v_cndmask_b32_dpp v162, v158, v162, vcc quad_perm:[1,0,3,2] row_mask:0xf bank_mask:0xf
    v_mfma_f32_16x16x32_bf16 v[120:123], a[52:55], v[48:51], v[120:123]
    ds_read_b128 v[140:143], v29 offset:9216
    v_cndmask_b32_dpp v163, v159, v163, vcc quad_perm:[1,0,3,2] row_mask:0xf bank_mask:0xf
    v_mfma_f32_16x16x32_bf16 v[120:123], a[76:79], v[52:55], v[120:123]
    v_cvt_pk_bf16_f32 v152, v116, v117
    v_cvt_pk_bf16_f32 v153, v118, v119
    v_mfma_f32_16x16x32_bf16 v[120:123], a[100:103], v[56:59], v[120:123]
    v_cvt_pk_bf16_f32 v78, v92, v93
    v_cvt_pk_bf16_f32 v79, v94, v95
    v_mfma_f32_16x16x32_bf16 v[120:123], a[124:127], v[60:63], v[120:123]
    buffer_load_dwordx4 v22, s[12:15], s27 offen offset:0 lds
    s_waitcnt lgkmcnt(4)
    v_mfma_f32_16x16x32_bf16 v[120:123], a[148:151], v[64:67], v[120:123]
    v_fmac_f32 v124, s45, v148
    v_fmac_f32 v125, s45, v149
    v_mfma_f32_16x16x32_bf16 v[120:123], a[172:175], v[68:71], v[120:123]
    v_fmac_f32 v126, s45, v150
    v_fmac_f32 v127, s45, v151
    v_mfma_f32_16x16x32_bf16 v[120:123], a[196:199], v[72:75], v[120:123]
    buffer_store_dwordx4 v[168:171], v30, s[20:23], s29 offen offset:128 nt
    v_mfma_f32_16x16x32_bf16 v[88:91], v[112:115], v[36:39], 0
    ds_read_b64_tr_b16 v[108:109], v10 offset:21632
    s_not_b64 vcc, vcc
    v_mfma_f32_16x16x32_bf16 v[124:127], a[8:11], v[40:43], v[124:127]
    ds_read_b64_tr_b16 v[110:111], v12 offset:21632
    s_mov_b32 s34, s31
    v_mfma_f32_16x16x32_bf16 v[124:127], a[32:35], v[44:47], v[124:127]
    ds_read_b128 v[132:135], v29 offset:4096
    s_mov_b32 s31, s32
    v_mfma_f32_16x16x32_bf16 v[124:127], a[56:59], v[48:51], v[124:127]
    ds_read_b128 v[144:147], v29 offset:10240
    s_mov_b32 s32, s33
    v_mfma_f32_16x16x32_bf16 v[124:127], a[80:83], v[52:55], v[124:127]
    v_cvt_pk_bf16_f32 v154, v120, v121
    v_cvt_pk_bf16_f32 v155, v122, v123
    v_mfma_f32_16x16x32_bf16 v[124:127], a[104:107], v[56:59], v[124:127]
    v_cvt_pk_bf16_f32 v80, v88, v89
    v_cvt_pk_bf16_f32 v81, v90, v91
    v_mfma_f32_16x16x32_bf16 v[124:127], a[128:131], v[60:63], v[124:127]
    buffer_load_dwordx4 v23, s[12:15], s27 offen offset:1024 lds
    s_mov_b32 s33, s55
    s_waitcnt lgkmcnt(4)
    v_mfma_f32_16x16x32_bf16 v[124:127], a[152:155], v[64:67], v[124:127]
    v_fmac_f32 v128, s45, v140
    v_fmac_f32 v129, s45, v141
    v_mfma_f32_16x16x32_bf16 v[124:127], a[176:179], v[68:71], v[124:127]
    v_fmac_f32 v130, s45, v142
    v_fmac_f32 v131, s45, v143
    v_mfma_f32_16x16x32_bf16 v[124:127], a[200:203], v[72:75], v[124:127]
    buffer_store_dwordx4 v[160:163], v30, s[20:23], s29 offen offset:256 nt
    s_mov_b32 s55, s34
    v_mfma_f32_16x16x32_bf16 v[92:95], v[104:107], v[36:39], 0
    ds_read_b64_tr_b16 v[112:113], v11 offset:21632
    s_mov_b32 s29, s28
    v_mfma_f32_16x16x32_bf16 v[128:131], a[12:15], v[40:43], v[128:131]
    ds_read_b64_tr_b16 v[114:115], v13 offset:21632
    s_add_u32 s28, s28, 196608
    v_mfma_f32_16x16x32_bf16 v[128:131], a[36:39], v[44:47], v[128:131]
    ds_read_b128 v[136:139], v29 offset:5120
    v_add_u32 v10, s31, v14
    v_mfma_f32_16x16x32_bf16 v[128:131], a[60:63], v[48:51], v[128:131]
    ds_read_b128 v[148:151], v29 offset:11264
    v_add_u32 v11, s31, v15
    v_mfma_f32_16x16x32_bf16 v[128:131], a[84:87], v[52:55], v[128:131]
    v_cvt_pk_bf16_f32 v156, v124, v125
    v_cvt_pk_bf16_f32 v157, v126, v127
    v_mfma_f32_16x16x32_bf16 v[128:131], a[108:111], v[56:59], v[128:131]
    v_cvt_pk_bf16_f32 v82, v92, v93
    v_cvt_pk_bf16_f32 v83, v94, v95
    v_mfma_f32_16x16x32_bf16 v[128:131], a[132:135], v[60:63], v[128:131]
    buffer_load_dwordx4 v24, s[12:15], s27 offen offset:2048 lds
    v_add_u32 v12, s31, v16
    s_waitcnt lgkmcnt(4)
    v_mfma_f32_16x16x32_bf16 v[128:131], a[156:159], v[64:67], v[128:131]
    v_fmac_f32 v132, s45, v144
    v_fmac_f32 v133, s45, v145
    v_mfma_f32_16x16x32_bf16 v[128:131], a[180:183], v[68:71], v[128:131]
    v_fmac_f32 v134, s45, v146
    v_fmac_f32 v135, s45, v147
    s_addk_i32 m0, 0xc00
    v_mfma_f32_16x16x32_bf16 v[128:131], a[204:207], v[72:75], v[128:131]
    buffer_load_dwordx4 v25, s[12:15], s27 offen offset:0 lds
    v_add_u32 v13, s31, v17
    v_mfma_f32_16x16x32_bf16 v[88:91], v[108:111], v[36:39], 0
    ds_read_b64_tr_b16 v[104:105], v10 offset:0
    v_mfma_f32_16x16x32_bf16 v[132:135], a[16:19], v[40:43], v[132:135]
    s_waitcnt vmcnt(20) lgkmcnt(1)
    s_barrier
    v_mfma_f32_16x16x32_bf16 v[132:135], a[40:43], v[44:47], v[132:135]
    ds_read_b64_tr_b16 v[106:107], v12 offset:0
    v_mfma_f32_16x16x32_bf16 v[132:135], a[64:67], v[48:51], v[132:135]
    ds_read_b128 v[116:119], v29 offset:12288
    v_mfma_f32_16x16x32_bf16 v[132:135], a[88:91], v[52:55], v[132:135]
    ds_read_b128 v[140:143], v29 offset:18432
    v_cvt_pk_bf16_f32 v158, v128, v129
    v_mfma_f32_16x16x32_bf16 v[132:135], a[112:115], v[56:59], v[132:135]
    v_cvt_pk_bf16_f32 v159, v130, v131
    v_cvt_pk_bf16_f32 v84, v88, v89
    v_mfma_f32_16x16x32_bf16 v[132:135], a[136:139], v[60:63], v[132:135]
    v_cvt_pk_bf16_f32 v85, v90, v91
    v_mfma_f32_16x16x32_bf16 v[132:135], a[160:163], v[64:67], v[132:135]
    v_fmac_f32 v136, s45, v148
    v_fmac_f32 v137, s45, v149
    v_mfma_f32_16x16x32_bf16 v[132:135], a[184:187], v[68:71], v[132:135]
    v_fmac_f32 v138, s45, v150
    v_fmac_f32 v139, s45, v151
    v_mfma_f32_16x16x32_bf16 v[132:135], a[208:211], v[72:75], v[132:135]
    buffer_load_dwordx4 v26, s[12:15], s27 offen offset:1024 lds
    v_mfma_f32_16x16x32_bf16 v[92:95], v[112:115], v[36:39], 0
    ds_read_b64_tr_b16 v[108:109], v11 offset:0
    v_cndmask_b32_dpp v164, v156, v152, vcc quad_perm:[1,0,3,2] row_mask:0xf bank_mask:0xf
    v_mfma_f32_16x16x32_bf16 v[136:139], a[20:23], v[40:43], v[136:139]
    ds_read_b64_tr_b16 v[110:111], v13 offset:0
    v_cndmask_b32_dpp v165, v157, v153, vcc quad_perm:[1,0,3,2] row_mask:0xf bank_mask:0xf
    v_mfma_f32_16x16x32_bf16 v[136:139], a[44:47], v[44:47], v[136:139]
    ds_read_b128 v[120:123], v29 offset:13312
    v_cndmask_b32_dpp v166, v158, v154, vcc quad_perm:[1,0,3,2] row_mask:0xf bank_mask:0xf
    v_mfma_f32_16x16x32_bf16 v[136:139], a[68:71], v[48:51], v[136:139]
    ds_read_b128 v[144:147], v29 offset:19456
    v_cndmask_b32_dpp v167, v159, v155, vcc quad_perm:[1,0,3,2] row_mask:0xf bank_mask:0xf
    v_mfma_f32_16x16x32_bf16 v[136:139], a[92:95], v[52:55], v[136:139]
    v_cvt_pk_bf16_f32 v160, v132, v133
    v_cvt_pk_bf16_f32 v161, v134, v135
    v_mfma_f32_16x16x32_bf16 v[136:139], a[116:119], v[56:59], v[136:139]
    v_cvt_pk_bf16_f32 v86, v92, v93
    v_cvt_pk_bf16_f32 v87, v94, v95
    v_mfma_f32_16x16x32_bf16 v[136:139], a[140:143], v[60:63], v[136:139]
    buffer_load_dwordx4 v27, s[12:15], s27 offen offset:2048 lds
    s_waitcnt lgkmcnt(4)
    v_mfma_f32_16x16x32_bf16 v[136:139], a[164:167], v[64:67], v[136:139]
    v_fmac_f32 v116, s45, v140
    v_fmac_f32 v117, s45, v141
    v_mfma_f32_16x16x32_bf16 v[136:139], a[188:191], v[68:71], v[136:139]
    v_fmac_f32 v118, s45, v142
    v_fmac_f32 v119, s45, v143
    v_mfma_f32_16x16x32_bf16 v[136:139], a[212:215], v[72:75], v[136:139]
    buffer_store_dwordx4 v[164:167], v30, s[20:23], s29 offen offset:0 nt
    v_mfma_f32_16x16x32_bf16 v[88:91], v[104:107], v[36:39], 0
    ds_read_b64_tr_b16 v[112:113], v10 offset:64
    v_cndmask_b32 v168, v152, v160, vcc
    v_mfma_f32_16x16x32_bf16 v[116:119], a[0:3], v[52:55], v[116:119]
    ds_read_b64_tr_b16 v[114:115], v12 offset:64
    v_cndmask_b32 v169, v153, v161, vcc
    v_mfma_f32_16x16x32_bf16 v[116:119], a[24:27], v[56:59], v[116:119]
    ds_read_b128 v[124:127], v29 offset:14336
    v_mfma_f32_16x16x32_bf16 v[116:119], a[48:51], v[60:63], v[116:119]
    ds_read_b128 v[148:151], v29 offset:20480
    v_mfma_f32_16x16x32_bf16 v[116:119], a[72:75], v[64:67], v[116:119]
    v_cvt_pk_bf16_f32 v162, v136, v137
    v_cvt_pk_bf16_f32 v163, v138, v139
    v_mfma_f32_16x16x32_bf16 v[116:119], a[96:99], v[68:71], v[116:119]
    v_cvt_pk_bf16_f32 v40, v88, v89
    v_cvt_pk_bf16_f32 v41, v90, v91
    v_mfma_f32_16x16x32_bf16 v[116:119], a[120:123], v[72:75], v[116:119]
    v_cndmask_b32 v170, v154, v162, vcc
    s_waitcnt lgkmcnt(4)
    v_mfma_f32_16x16x32_bf16 v[116:119], a[144:147], v[76:79], v[116:119]
    v_fmac_f32 v120, s45, v144
    v_fmac_f32 v121, s45, v145
    v_mfma_f32_16x16x32_bf16 v[116:119], a[168:171], v[80:83], v[116:119]
    v_fmac_f32 v122, s45, v146
    v_fmac_f32 v123, s45, v147
    v_mfma_f32_16x16x32_bf16 v[116:119], a[192:195], v[84:87], v[116:119]
    v_cndmask_b32 v171, v155, v163, vcc
    s_not_b64 vcc, vcc
    v_mfma_f32_16x16x32_bf16 v[92:95], v[108:111], v[36:39], 0
    ds_read_b64_tr_b16 v[104:105], v11 offset:64
    v_cndmask_b32_dpp v160, v156, v160, vcc quad_perm:[1,0,3,2] row_mask:0xf bank_mask:0xf
    v_mfma_f32_16x16x32_bf16 v[120:123], a[4:7], v[52:55], v[120:123]
    ds_read_b64_tr_b16 v[106:107], v13 offset:64
    v_cndmask_b32_dpp v161, v157, v161, vcc quad_perm:[1,0,3,2] row_mask:0xf bank_mask:0xf
    v_mfma_f32_16x16x32_bf16 v[120:123], a[28:31], v[56:59], v[120:123]
    ds_read_b128 v[128:131], v29 offset:15360
    v_cndmask_b32_dpp v162, v158, v162, vcc quad_perm:[1,0,3,2] row_mask:0xf bank_mask:0xf
    v_mfma_f32_16x16x32_bf16 v[120:123], a[52:55], v[60:63], v[120:123]
    ds_read_b128 v[140:143], v29 offset:21504
    v_cndmask_b32_dpp v163, v159, v163, vcc quad_perm:[1,0,3,2] row_mask:0xf bank_mask:0xf
    v_mfma_f32_16x16x32_bf16 v[120:123], a[76:79], v[64:67], v[120:123]
    v_cvt_pk_bf16_f32 v152, v116, v117
    v_cvt_pk_bf16_f32 v153, v118, v119
    v_mfma_f32_16x16x32_bf16 v[120:123], a[100:103], v[68:71], v[120:123]
    v_cvt_pk_bf16_f32 v42, v92, v93
    v_cvt_pk_bf16_f32 v43, v94, v95
    v_mfma_f32_16x16x32_bf16 v[120:123], a[124:127], v[72:75], v[120:123]
    buffer_load_dwordx4 v28, s[12:15], s27 offen offset:3072 lds
    s_waitcnt lgkmcnt(4)
    v_mfma_f32_16x16x32_bf16 v[120:123], a[148:151], v[76:79], v[120:123]
    v_fmac_f32 v124, s45, v148
    v_fmac_f32 v125, s45, v149
    v_mfma_f32_16x16x32_bf16 v[120:123], a[172:175], v[80:83], v[120:123]
    v_fmac_f32 v126, s45, v150
    v_fmac_f32 v127, s45, v151
    v_mfma_f32_16x16x32_bf16 v[120:123], a[196:199], v[84:87], v[120:123]
    buffer_store_dwordx4 v[168:171], v30, s[20:23], s29 offen offset:128 nt
    s_add_u32 s27, s27, 393216
    v_mfma_f32_16x16x32_bf16 v[88:91], v[112:115], v[36:39], 0
    ds_read_b64_tr_b16 v[108:109], v10 offset:128
    s_not_b64 vcc, vcc
    v_mfma_f32_16x16x32_bf16 v[124:127], a[8:11], v[52:55], v[124:127]
    ds_read_b64_tr_b16 v[110:111], v12 offset:128
    v_mfma_f32_16x16x32_bf16 v[124:127], a[32:35], v[56:59], v[124:127]
    ds_read_b128 v[132:135], v29 offset:16384
    v_mfma_f32_16x16x32_bf16 v[124:127], a[56:59], v[60:63], v[124:127]
    ds_read_b128 v[144:147], v29 offset:22528
    v_mfma_f32_16x16x32_bf16 v[124:127], a[80:83], v[64:67], v[124:127]
    v_cvt_pk_bf16_f32 v154, v120, v121
    v_cvt_pk_bf16_f32 v155, v122, v123
    v_mfma_f32_16x16x32_bf16 v[124:127], a[104:107], v[68:71], v[124:127]
    v_cvt_pk_bf16_f32 v44, v88, v89
    v_cvt_pk_bf16_f32 v45, v90, v91
    v_mfma_f32_16x16x32_bf16 v[124:127], a[128:131], v[72:75], v[124:127]
    s_waitcnt lgkmcnt(4)
    v_mfma_f32_16x16x32_bf16 v[124:127], a[152:155], v[76:79], v[124:127]
    v_fmac_f32 v128, s45, v140
    v_fmac_f32 v129, s45, v141
    v_mfma_f32_16x16x32_bf16 v[124:127], a[176:179], v[80:83], v[124:127]
    v_fmac_f32 v130, s45, v142
    v_fmac_f32 v131, s45, v143
    v_mfma_f32_16x16x32_bf16 v[124:127], a[200:203], v[84:87], v[124:127]
    buffer_store_dwordx4 v[160:163], v30, s[20:23], s29 offen offset:256 nt
    v_mfma_f32_16x16x32_bf16 v[92:95], v[104:107], v[36:39], 0
    ds_read_b64_tr_b16 v[112:113], v11 offset:128
    s_mov_b32 s29, s28
    v_mfma_f32_16x16x32_bf16 v[128:131], a[12:15], v[52:55], v[128:131]
    ds_read_b64_tr_b16 v[114:115], v13 offset:128
    s_add_u32 s28, s28, 196608
    v_mfma_f32_16x16x32_bf16 v[128:131], a[36:39], v[56:59], v[128:131]
    ds_read_b128 v[136:139], v29 offset:17408
    v_mfma_f32_16x16x32_bf16 v[128:131], a[60:63], v[60:63], v[128:131]
    ds_read_b128 v[148:151], v29 offset:23552
    v_mfma_f32_16x16x32_bf16 v[128:131], a[84:87], v[64:67], v[128:131]
    v_cvt_pk_bf16_f32 v156, v124, v125
    v_cvt_pk_bf16_f32 v157, v126, v127
    v_mfma_f32_16x16x32_bf16 v[128:131], a[108:111], v[68:71], v[128:131]
    v_cvt_pk_bf16_f32 v46, v92, v93
    v_cvt_pk_bf16_f32 v47, v94, v95
    v_mfma_f32_16x16x32_bf16 v[128:131], a[132:135], v[72:75], v[128:131]
    s_waitcnt lgkmcnt(4)
    v_mfma_f32_16x16x32_bf16 v[128:131], a[156:159], v[76:79], v[128:131]
    v_fmac_f32 v132, s45, v144
    v_fmac_f32 v133, s45, v145
    v_mfma_f32_16x16x32_bf16 v[128:131], a[180:183], v[80:83], v[128:131]
    v_fmac_f32 v134, s45, v146
    v_fmac_f32 v135, s45, v147
    v_mfma_f32_16x16x32_bf16 v[128:131], a[204:207], v[84:87], v[128:131]
    v_mfma_f32_16x16x32_bf16 v[88:91], v[108:111], v[36:39], 0
    ds_read_b64_tr_b16 v[104:105], v10 offset:7168
    v_mfma_f32_16x16x32_bf16 v[132:135], a[16:19], v[52:55], v[132:135]
    s_waitcnt lgkmcnt(1)
    s_barrier
    v_mfma_f32_16x16x32_bf16 v[132:135], a[40:43], v[56:59], v[132:135]
    ds_read_b64_tr_b16 v[106:107], v12 offset:7168
    v_mfma_f32_16x16x32_bf16 v[132:135], a[64:67], v[60:63], v[132:135]
    ds_read_b128 v[116:119], v29 offset:0
    v_mfma_f32_16x16x32_bf16 v[132:135], a[88:91], v[64:67], v[132:135]
    ds_read_b128 v[140:143], v29 offset:6144
    v_cvt_pk_bf16_f32 v158, v128, v129
    v_mfma_f32_16x16x32_bf16 v[132:135], a[112:115], v[68:71], v[132:135]
    v_cvt_pk_bf16_f32 v159, v130, v131
    v_cvt_pk_bf16_f32 v48, v88, v89
    v_mfma_f32_16x16x32_bf16 v[132:135], a[136:139], v[72:75], v[132:135]
    v_cvt_pk_bf16_f32 v49, v90, v91
    v_mfma_f32_16x16x32_bf16 v[132:135], a[160:163], v[76:79], v[132:135]
    v_fmac_f32 v136, s45, v148
    v_fmac_f32 v137, s45, v149
    v_mfma_f32_16x16x32_bf16 v[132:135], a[184:187], v[80:83], v[132:135]
    v_fmac_f32 v138, s45, v150
    v_fmac_f32 v139, s45, v151
    v_mfma_f32_16x16x32_bf16 v[132:135], a[208:211], v[84:87], v[132:135]
    v_mfma_f32_16x16x32_bf16 v[92:95], v[112:115], v[36:39], 0
    ds_read_b64_tr_b16 v[108:109], v11 offset:7168
    v_cndmask_b32_dpp v164, v156, v152, vcc quad_perm:[1,0,3,2] row_mask:0xf bank_mask:0xf
    v_mfma_f32_16x16x32_bf16 v[136:139], a[20:23], v[52:55], v[136:139]
    ds_read_b64_tr_b16 v[110:111], v13 offset:7168
    v_cndmask_b32_dpp v165, v157, v153, vcc quad_perm:[1,0,3,2] row_mask:0xf bank_mask:0xf
    v_mfma_f32_16x16x32_bf16 v[136:139], a[44:47], v[56:59], v[136:139]
    ds_read_b128 v[120:123], v29 offset:1024
    v_cndmask_b32_dpp v166, v158, v154, vcc quad_perm:[1,0,3,2] row_mask:0xf bank_mask:0xf
    v_mfma_f32_16x16x32_bf16 v[136:139], a[68:71], v[60:63], v[136:139]
    ds_read_b128 v[144:147], v29 offset:7168
    v_cndmask_b32_dpp v167, v159, v155, vcc quad_perm:[1,0,3,2] row_mask:0xf bank_mask:0xf
    v_mfma_f32_16x16x32_bf16 v[136:139], a[92:95], v[64:67], v[136:139]
    v_cvt_pk_bf16_f32 v160, v132, v133
    v_cvt_pk_bf16_f32 v161, v134, v135
    v_mfma_f32_16x16x32_bf16 v[136:139], a[116:119], v[68:71], v[136:139]
    v_cvt_pk_bf16_f32 v50, v92, v93
    v_cvt_pk_bf16_f32 v51, v94, v95
    v_mfma_f32_16x16x32_bf16 v[136:139], a[140:143], v[72:75], v[136:139]
    s_waitcnt lgkmcnt(4)
    v_mfma_f32_16x16x32_bf16 v[136:139], a[164:167], v[76:79], v[136:139]
    v_fmac_f32 v116, s45, v140
    v_fmac_f32 v117, s45, v141
    v_mfma_f32_16x16x32_bf16 v[136:139], a[188:191], v[80:83], v[136:139]
    v_fmac_f32 v118, s45, v142
    v_fmac_f32 v119, s45, v143
    v_mfma_f32_16x16x32_bf16 v[136:139], a[212:215], v[84:87], v[136:139]
    buffer_store_dwordx4 v[164:167], v30, s[20:23], s29 offen offset:0 nt
    v_mfma_f32_16x16x32_bf16 v[88:91], v[104:107], v[36:39], 0
    ds_read_b64_tr_b16 v[112:113], v10 offset:7232
    v_cndmask_b32 v168, v152, v160, vcc
    v_mfma_f32_16x16x32_bf16 v[116:119], a[0:3], v[64:67], v[116:119]
    ds_read_b64_tr_b16 v[114:115], v12 offset:7232
    v_cndmask_b32 v169, v153, v161, vcc
    v_mfma_f32_16x16x32_bf16 v[116:119], a[24:27], v[68:71], v[116:119]
    ds_read_b128 v[124:127], v29 offset:2048
    s_add_u32 m0, s33, s58
    v_mfma_f32_16x16x32_bf16 v[116:119], a[48:51], v[72:75], v[116:119]
    ds_read_b128 v[148:151], v29 offset:8192
    v_mfma_f32_16x16x32_bf16 v[116:119], a[72:75], v[76:79], v[116:119]
    v_cvt_pk_bf16_f32 v162, v136, v137
    v_cvt_pk_bf16_f32 v163, v138, v139
    v_mfma_f32_16x16x32_bf16 v[116:119], a[96:99], v[80:83], v[116:119]
    v_cvt_pk_bf16_f32 v52, v88, v89
    v_cvt_pk_bf16_f32 v53, v90, v91
    v_mfma_f32_16x16x32_bf16 v[116:119], a[120:123], v[84:87], v[116:119]
    v_cndmask_b32 v170, v154, v162, vcc
    s_waitcnt lgkmcnt(4)
    v_mfma_f32_16x16x32_bf16 v[116:119], a[144:147], v[40:43], v[116:119]
    v_fmac_f32 v120, s45, v144
    v_fmac_f32 v121, s45, v145
    v_mfma_f32_16x16x32_bf16 v[116:119], a[168:171], v[44:47], v[116:119]
    v_fmac_f32 v122, s45, v146
    v_fmac_f32 v123, s45, v147
    v_mfma_f32_16x16x32_bf16 v[116:119], a[192:195], v[48:51], v[116:119]
    v_cndmask_b32 v171, v155, v163, vcc
    s_not_b64 vcc, vcc
    v_mfma_f32_16x16x32_bf16 v[92:95], v[108:111], v[36:39], 0
    ds_read_b64_tr_b16 v[104:105], v11 offset:7232
    v_cndmask_b32_dpp v160, v156, v160, vcc quad_perm:[1,0,3,2] row_mask:0xf bank_mask:0xf
    v_mfma_f32_16x16x32_bf16 v[120:123], a[4:7], v[64:67], v[120:123]
    ds_read_b64_tr_b16 v[106:107], v13 offset:7232
    v_cndmask_b32_dpp v161, v157, v161, vcc quad_perm:[1,0,3,2] row_mask:0xf bank_mask:0xf
    v_mfma_f32_16x16x32_bf16 v[120:123], a[28:31], v[68:71], v[120:123]
    ds_read_b128 v[128:131], v29 offset:3072
    v_cndmask_b32_dpp v162, v158, v162, vcc quad_perm:[1,0,3,2] row_mask:0xf bank_mask:0xf
    v_mfma_f32_16x16x32_bf16 v[120:123], a[52:55], v[72:75], v[120:123]
    ds_read_b128 v[140:143], v29 offset:9216
    v_cndmask_b32_dpp v163, v159, v163, vcc quad_perm:[1,0,3,2] row_mask:0xf bank_mask:0xf
    v_mfma_f32_16x16x32_bf16 v[120:123], a[76:79], v[76:79], v[120:123]
    v_cvt_pk_bf16_f32 v152, v116, v117
    v_cvt_pk_bf16_f32 v153, v118, v119
    v_mfma_f32_16x16x32_bf16 v[120:123], a[100:103], v[80:83], v[120:123]
    v_cvt_pk_bf16_f32 v54, v92, v93
    v_cvt_pk_bf16_f32 v55, v94, v95
    v_mfma_f32_16x16x32_bf16 v[120:123], a[124:127], v[84:87], v[120:123]
    buffer_load_dwordx4 v22, s[12:15], s27 offen offset:0 lds
    s_waitcnt lgkmcnt(4)
    v_mfma_f32_16x16x32_bf16 v[120:123], a[148:151], v[40:43], v[120:123]
    v_fmac_f32 v124, s45, v148
    v_fmac_f32 v125, s45, v149
    v_mfma_f32_16x16x32_bf16 v[120:123], a[172:175], v[44:47], v[120:123]
    v_fmac_f32 v126, s45, v150
    v_fmac_f32 v127, s45, v151
    v_mfma_f32_16x16x32_bf16 v[120:123], a[196:199], v[48:51], v[120:123]
    buffer_store_dwordx4 v[168:171], v30, s[20:23], s29 offen offset:128 nt
    v_mfma_f32_16x16x32_bf16 v[88:91], v[112:115], v[36:39], 0
    ds_read_b64_tr_b16 v[108:109], v10 offset:7296
    s_not_b64 vcc, vcc
    v_mfma_f32_16x16x32_bf16 v[124:127], a[8:11], v[64:67], v[124:127]
    ds_read_b64_tr_b16 v[110:111], v12 offset:7296
    v_mfma_f32_16x16x32_bf16 v[124:127], a[32:35], v[68:71], v[124:127]
    ds_read_b128 v[132:135], v29 offset:4096
    v_mfma_f32_16x16x32_bf16 v[124:127], a[56:59], v[72:75], v[124:127]
    ds_read_b128 v[144:147], v29 offset:10240
    v_mfma_f32_16x16x32_bf16 v[124:127], a[80:83], v[76:79], v[124:127]
    v_cvt_pk_bf16_f32 v154, v120, v121
    v_cvt_pk_bf16_f32 v155, v122, v123
    v_mfma_f32_16x16x32_bf16 v[124:127], a[104:107], v[80:83], v[124:127]
    v_cvt_pk_bf16_f32 v56, v88, v89
    v_cvt_pk_bf16_f32 v57, v90, v91
    v_mfma_f32_16x16x32_bf16 v[124:127], a[128:131], v[84:87], v[124:127]
    buffer_load_dwordx4 v23, s[12:15], s27 offen offset:1024 lds
    s_waitcnt lgkmcnt(4)
    v_mfma_f32_16x16x32_bf16 v[124:127], a[152:155], v[40:43], v[124:127]
    v_fmac_f32 v128, s45, v140
    v_fmac_f32 v129, s45, v141
    v_mfma_f32_16x16x32_bf16 v[124:127], a[176:179], v[44:47], v[124:127]
    v_fmac_f32 v130, s45, v142
    v_fmac_f32 v131, s45, v143
    v_mfma_f32_16x16x32_bf16 v[124:127], a[200:203], v[48:51], v[124:127]
    buffer_store_dwordx4 v[160:163], v30, s[20:23], s29 offen offset:256 nt
    v_mfma_f32_16x16x32_bf16 v[92:95], v[104:107], v[36:39], 0
    ds_read_b64_tr_b16 v[112:113], v11 offset:7296
    s_mov_b32 s29, s28
    v_mfma_f32_16x16x32_bf16 v[128:131], a[12:15], v[64:67], v[128:131]
    ds_read_b64_tr_b16 v[114:115], v13 offset:7296
    s_add_u32 s28, s28, 196608
    v_mfma_f32_16x16x32_bf16 v[128:131], a[36:39], v[68:71], v[128:131]
    ds_read_b128 v[136:139], v29 offset:5120
    v_mfma_f32_16x16x32_bf16 v[128:131], a[60:63], v[72:75], v[128:131]
    ds_read_b128 v[148:151], v29 offset:11264
    v_mfma_f32_16x16x32_bf16 v[128:131], a[84:87], v[76:79], v[128:131]
    v_cvt_pk_bf16_f32 v156, v124, v125
    v_cvt_pk_bf16_f32 v157, v126, v127
    v_mfma_f32_16x16x32_bf16 v[128:131], a[108:111], v[80:83], v[128:131]
    v_cvt_pk_bf16_f32 v58, v92, v93
    v_cvt_pk_bf16_f32 v59, v94, v95
    v_mfma_f32_16x16x32_bf16 v[128:131], a[132:135], v[84:87], v[128:131]
    buffer_load_dwordx4 v24, s[12:15], s27 offen offset:2048 lds
    s_waitcnt lgkmcnt(4)
    v_mfma_f32_16x16x32_bf16 v[128:131], a[156:159], v[40:43], v[128:131]
    v_fmac_f32 v132, s45, v144
    v_fmac_f32 v133, s45, v145
    v_mfma_f32_16x16x32_bf16 v[128:131], a[180:183], v[44:47], v[128:131]
    v_fmac_f32 v134, s45, v146
    v_fmac_f32 v135, s45, v147
    s_addk_i32 m0, 0xc00
    v_mfma_f32_16x16x32_bf16 v[128:131], a[204:207], v[48:51], v[128:131]
    buffer_load_dwordx4 v25, s[12:15], s27 offen offset:0 lds
    v_mfma_f32_16x16x32_bf16 v[88:91], v[108:111], v[36:39], 0
    ds_read_b64_tr_b16 v[104:105], v10 offset:14336
    v_mfma_f32_16x16x32_bf16 v[132:135], a[16:19], v[64:67], v[132:135]
    s_waitcnt vmcnt(26) lgkmcnt(1)
    s_barrier
    v_mfma_f32_16x16x32_bf16 v[132:135], a[40:43], v[68:71], v[132:135]
    ds_read_b64_tr_b16 v[106:107], v12 offset:14336
    v_mfma_f32_16x16x32_bf16 v[132:135], a[64:67], v[72:75], v[132:135]
    ds_read_b128 v[116:119], v29 offset:12288
    v_mfma_f32_16x16x32_bf16 v[132:135], a[88:91], v[76:79], v[132:135]
    ds_read_b128 v[140:143], v29 offset:18432
    v_cvt_pk_bf16_f32 v158, v128, v129
    v_mfma_f32_16x16x32_bf16 v[132:135], a[112:115], v[80:83], v[132:135]
    v_cvt_pk_bf16_f32 v159, v130, v131
    v_cvt_pk_bf16_f32 v60, v88, v89
    v_mfma_f32_16x16x32_bf16 v[132:135], a[136:139], v[84:87], v[132:135]
    v_cvt_pk_bf16_f32 v61, v90, v91
    v_mfma_f32_16x16x32_bf16 v[132:135], a[160:163], v[40:43], v[132:135]
    v_fmac_f32 v136, s45, v148
    v_fmac_f32 v137, s45, v149
    v_mfma_f32_16x16x32_bf16 v[132:135], a[184:187], v[44:47], v[132:135]
    v_fmac_f32 v138, s45, v150
    v_fmac_f32 v139, s45, v151
    v_mfma_f32_16x16x32_bf16 v[132:135], a[208:211], v[48:51], v[132:135]
    buffer_load_dwordx4 v26, s[12:15], s27 offen offset:1024 lds
    v_mfma_f32_16x16x32_bf16 v[92:95], v[112:115], v[36:39], 0
    ds_read_b64_tr_b16 v[108:109], v11 offset:14336
    v_cndmask_b32_dpp v164, v156, v152, vcc quad_perm:[1,0,3,2] row_mask:0xf bank_mask:0xf
    v_mfma_f32_16x16x32_bf16 v[136:139], a[20:23], v[64:67], v[136:139]
    ds_read_b64_tr_b16 v[110:111], v13 offset:14336
    v_cndmask_b32_dpp v165, v157, v153, vcc quad_perm:[1,0,3,2] row_mask:0xf bank_mask:0xf
    v_mfma_f32_16x16x32_bf16 v[136:139], a[44:47], v[68:71], v[136:139]
    ds_read_b128 v[120:123], v29 offset:13312
    v_cndmask_b32_dpp v166, v158, v154, vcc quad_perm:[1,0,3,2] row_mask:0xf bank_mask:0xf
    v_mfma_f32_16x16x32_bf16 v[136:139], a[68:71], v[72:75], v[136:139]
    ds_read_b128 v[144:147], v29 offset:19456
    v_cndmask_b32_dpp v167, v159, v155, vcc quad_perm:[1,0,3,2] row_mask:0xf bank_mask:0xf
    v_mfma_f32_16x16x32_bf16 v[136:139], a[92:95], v[76:79], v[136:139]
    v_cvt_pk_bf16_f32 v160, v132, v133
    v_cvt_pk_bf16_f32 v161, v134, v135
    v_mfma_f32_16x16x32_bf16 v[136:139], a[116:119], v[80:83], v[136:139]
    v_cvt_pk_bf16_f32 v62, v92, v93
    v_cvt_pk_bf16_f32 v63, v94, v95
    v_mfma_f32_16x16x32_bf16 v[136:139], a[140:143], v[84:87], v[136:139]
    buffer_load_dwordx4 v27, s[12:15], s27 offen offset:2048 lds
    s_waitcnt lgkmcnt(4)
    v_mfma_f32_16x16x32_bf16 v[136:139], a[164:167], v[40:43], v[136:139]
    v_fmac_f32 v116, s45, v140
    v_fmac_f32 v117, s45, v141
    v_mfma_f32_16x16x32_bf16 v[136:139], a[188:191], v[44:47], v[136:139]
    v_fmac_f32 v118, s45, v142
    v_fmac_f32 v119, s45, v143
    v_mfma_f32_16x16x32_bf16 v[136:139], a[212:215], v[48:51], v[136:139]
    buffer_store_dwordx4 v[164:167], v30, s[20:23], s29 offen offset:0 nt
    v_mfma_f32_16x16x32_bf16 v[88:91], v[104:107], v[36:39], 0
    ds_read_b64_tr_b16 v[112:113], v10 offset:14400
    v_cndmask_b32 v168, v152, v160, vcc
    v_mfma_f32_16x16x32_bf16 v[116:119], a[0:3], v[76:79], v[116:119]
    ds_read_b64_tr_b16 v[114:115], v12 offset:14400
    v_cndmask_b32 v169, v153, v161, vcc
    v_mfma_f32_16x16x32_bf16 v[116:119], a[24:27], v[80:83], v[116:119]
    ds_read_b128 v[124:127], v29 offset:14336
    v_mfma_f32_16x16x32_bf16 v[116:119], a[48:51], v[84:87], v[116:119]
    ds_read_b128 v[148:151], v29 offset:20480
    v_mfma_f32_16x16x32_bf16 v[116:119], a[72:75], v[40:43], v[116:119]
    v_cvt_pk_bf16_f32 v162, v136, v137
    v_cvt_pk_bf16_f32 v163, v138, v139
    v_mfma_f32_16x16x32_bf16 v[116:119], a[96:99], v[44:47], v[116:119]
    v_cvt_pk_bf16_f32 v64, v88, v89
    v_cvt_pk_bf16_f32 v65, v90, v91
    v_mfma_f32_16x16x32_bf16 v[116:119], a[120:123], v[48:51], v[116:119]
    v_cndmask_b32 v170, v154, v162, vcc
    s_waitcnt lgkmcnt(4)
    v_mfma_f32_16x16x32_bf16 v[116:119], a[144:147], v[52:55], v[116:119]
    v_fmac_f32 v120, s45, v144
    v_fmac_f32 v121, s45, v145
    v_mfma_f32_16x16x32_bf16 v[116:119], a[168:171], v[56:59], v[116:119]
    v_fmac_f32 v122, s45, v146
    v_fmac_f32 v123, s45, v147
    v_mfma_f32_16x16x32_bf16 v[116:119], a[192:195], v[60:63], v[116:119]
    v_cndmask_b32 v171, v155, v163, vcc
    s_not_b64 vcc, vcc
    v_mfma_f32_16x16x32_bf16 v[92:95], v[108:111], v[36:39], 0
    ds_read_b64_tr_b16 v[104:105], v11 offset:14400
    v_cndmask_b32_dpp v160, v156, v160, vcc quad_perm:[1,0,3,2] row_mask:0xf bank_mask:0xf
    v_mfma_f32_16x16x32_bf16 v[120:123], a[4:7], v[76:79], v[120:123]
    ds_read_b64_tr_b16 v[106:107], v13 offset:14400
    v_cndmask_b32_dpp v161, v157, v161, vcc quad_perm:[1,0,3,2] row_mask:0xf bank_mask:0xf
    v_mfma_f32_16x16x32_bf16 v[120:123], a[28:31], v[80:83], v[120:123]
    ds_read_b128 v[128:131], v29 offset:15360
    v_cndmask_b32_dpp v162, v158, v162, vcc quad_perm:[1,0,3,2] row_mask:0xf bank_mask:0xf
    v_mfma_f32_16x16x32_bf16 v[120:123], a[52:55], v[84:87], v[120:123]
    ds_read_b128 v[140:143], v29 offset:21504
    v_cndmask_b32_dpp v163, v159, v163, vcc quad_perm:[1,0,3,2] row_mask:0xf bank_mask:0xf
    v_mfma_f32_16x16x32_bf16 v[120:123], a[76:79], v[40:43], v[120:123]
    v_cvt_pk_bf16_f32 v152, v116, v117
    v_cvt_pk_bf16_f32 v153, v118, v119
    v_mfma_f32_16x16x32_bf16 v[120:123], a[100:103], v[44:47], v[120:123]
    v_cvt_pk_bf16_f32 v66, v92, v93
    v_cvt_pk_bf16_f32 v67, v94, v95
    v_mfma_f32_16x16x32_bf16 v[120:123], a[124:127], v[48:51], v[120:123]
    buffer_load_dwordx4 v28, s[12:15], s27 offen offset:3072 lds
    s_waitcnt lgkmcnt(4)
    v_mfma_f32_16x16x32_bf16 v[120:123], a[148:151], v[52:55], v[120:123]
    v_fmac_f32 v124, s45, v148
    v_fmac_f32 v125, s45, v149
    v_mfma_f32_16x16x32_bf16 v[120:123], a[172:175], v[56:59], v[120:123]
    v_fmac_f32 v126, s45, v150
    v_fmac_f32 v127, s45, v151
    v_mfma_f32_16x16x32_bf16 v[120:123], a[196:199], v[60:63], v[120:123]
    buffer_store_dwordx4 v[168:171], v30, s[20:23], s29 offen offset:128 nt
    s_add_u32 s27, s27, 393216
    v_mfma_f32_16x16x32_bf16 v[88:91], v[112:115], v[36:39], 0
    ds_read_b64_tr_b16 v[108:109], v10 offset:14464
    s_not_b64 vcc, vcc
    v_mfma_f32_16x16x32_bf16 v[124:127], a[8:11], v[76:79], v[124:127]
    ds_read_b64_tr_b16 v[110:111], v12 offset:14464
    s_sub_u32 s30, s30, 1
    v_mfma_f32_16x16x32_bf16 v[124:127], a[32:35], v[80:83], v[124:127]
    ds_read_b128 v[132:135], v29 offset:16384
    v_mfma_f32_16x16x32_bf16 v[124:127], a[56:59], v[84:87], v[124:127]
    ds_read_b128 v[144:147], v29 offset:22528
    v_mfma_f32_16x16x32_bf16 v[124:127], a[80:83], v[40:43], v[124:127]
    v_cvt_pk_bf16_f32 v154, v120, v121
    v_cvt_pk_bf16_f32 v155, v122, v123
    v_mfma_f32_16x16x32_bf16 v[124:127], a[104:107], v[44:47], v[124:127]
    v_cvt_pk_bf16_f32 v68, v88, v89
    v_cvt_pk_bf16_f32 v69, v90, v91
    v_mfma_f32_16x16x32_bf16 v[124:127], a[128:131], v[48:51], v[124:127]
    s_waitcnt lgkmcnt(4)
    v_mfma_f32_16x16x32_bf16 v[124:127], a[152:155], v[52:55], v[124:127]
    v_fmac_f32 v128, s45, v140
    v_fmac_f32 v129, s45, v141
    v_mfma_f32_16x16x32_bf16 v[124:127], a[176:179], v[56:59], v[124:127]
    v_fmac_f32 v130, s45, v142
    v_fmac_f32 v131, s45, v143
    v_mfma_f32_16x16x32_bf16 v[124:127], a[200:203], v[60:63], v[124:127]
    buffer_store_dwordx4 v[160:163], v30, s[20:23], s29 offen offset:256 nt
    v_mfma_f32_16x16x32_bf16 v[92:95], v[104:107], v[36:39], 0
    ds_read_b64_tr_b16 v[112:113], v11 offset:14464
    s_mov_b32 s29, s28
    v_mfma_f32_16x16x32_bf16 v[128:131], a[12:15], v[76:79], v[128:131]
    ds_read_b64_tr_b16 v[114:115], v13 offset:14464
    s_add_u32 s28, s28, 196608
    v_mfma_f32_16x16x32_bf16 v[128:131], a[36:39], v[80:83], v[128:131]
    ds_read_b128 v[136:139], v29 offset:17408
    v_mfma_f32_16x16x32_bf16 v[128:131], a[60:63], v[84:87], v[128:131]
    ds_read_b128 v[148:151], v29 offset:23552
    v_mfma_f32_16x16x32_bf16 v[128:131], a[84:87], v[40:43], v[128:131]
    v_cvt_pk_bf16_f32 v156, v124, v125
    v_cvt_pk_bf16_f32 v157, v126, v127
    v_mfma_f32_16x16x32_bf16 v[128:131], a[108:111], v[44:47], v[128:131]
    v_cvt_pk_bf16_f32 v70, v92, v93
    v_cvt_pk_bf16_f32 v71, v94, v95
    v_mfma_f32_16x16x32_bf16 v[128:131], a[132:135], v[48:51], v[128:131]
    s_waitcnt lgkmcnt(4)
    v_mfma_f32_16x16x32_bf16 v[128:131], a[156:159], v[52:55], v[128:131]
    v_fmac_f32 v132, s45, v144
    v_fmac_f32 v133, s45, v145
    v_mfma_f32_16x16x32_bf16 v[128:131], a[180:183], v[56:59], v[128:131]
    v_fmac_f32 v134, s45, v146
    v_fmac_f32 v135, s45, v147
    v_mfma_f32_16x16x32_bf16 v[128:131], a[204:207], v[60:63], v[128:131]
    v_mfma_f32_16x16x32_bf16 v[88:91], v[108:111], v[36:39], 0
    ds_read_b64_tr_b16 v[104:105], v10 offset:21504
    v_mfma_f32_16x16x32_bf16 v[132:135], a[16:19], v[76:79], v[132:135]
    s_waitcnt lgkmcnt(1)
    s_barrier
    v_mfma_f32_16x16x32_bf16 v[132:135], a[40:43], v[80:83], v[132:135]
    ds_read_b64_tr_b16 v[106:107], v12 offset:21504
    v_mfma_f32_16x16x32_bf16 v[132:135], a[64:67], v[84:87], v[132:135]
    ds_read_b128 v[116:119], v29 offset:0
    v_mfma_f32_16x16x32_bf16 v[132:135], a[88:91], v[40:43], v[132:135]
    ds_read_b128 v[140:143], v29 offset:6144
    v_cvt_pk_bf16_f32 v158, v128, v129
    v_mfma_f32_16x16x32_bf16 v[132:135], a[112:115], v[44:47], v[132:135]
    v_cvt_pk_bf16_f32 v159, v130, v131
    v_cvt_pk_bf16_f32 v72, v88, v89
    v_mfma_f32_16x16x32_bf16 v[132:135], a[136:139], v[48:51], v[132:135]
    v_cvt_pk_bf16_f32 v73, v90, v91
    v_mfma_f32_16x16x32_bf16 v[132:135], a[160:163], v[52:55], v[132:135]
    v_fmac_f32 v136, s45, v148
    v_fmac_f32 v137, s45, v149
    v_mfma_f32_16x16x32_bf16 v[132:135], a[184:187], v[56:59], v[132:135]
    v_fmac_f32 v138, s45, v150
    v_fmac_f32 v139, s45, v151
    v_mfma_f32_16x16x32_bf16 v[132:135], a[208:211], v[60:63], v[132:135]
    v_mfma_f32_16x16x32_bf16 v[92:95], v[112:115], v[36:39], 0
    ds_read_b64_tr_b16 v[108:109], v11 offset:21504
    v_cndmask_b32_dpp v164, v156, v152, vcc quad_perm:[1,0,3,2] row_mask:0xf bank_mask:0xf
    v_mfma_f32_16x16x32_bf16 v[136:139], a[20:23], v[76:79], v[136:139]
    ds_read_b64_tr_b16 v[110:111], v13 offset:21504
    v_cndmask_b32_dpp v165, v157, v153, vcc quad_perm:[1,0,3,2] row_mask:0xf bank_mask:0xf
    v_mfma_f32_16x16x32_bf16 v[136:139], a[44:47], v[80:83], v[136:139]
    ds_read_b128 v[120:123], v29 offset:1024
    v_cndmask_b32_dpp v166, v158, v154, vcc quad_perm:[1,0,3,2] row_mask:0xf bank_mask:0xf
    v_mfma_f32_16x16x32_bf16 v[136:139], a[68:71], v[84:87], v[136:139]
    ds_read_b128 v[144:147], v29 offset:7168
    v_cndmask_b32_dpp v167, v159, v155, vcc quad_perm:[1,0,3,2] row_mask:0xf bank_mask:0xf
    v_mfma_f32_16x16x32_bf16 v[136:139], a[92:95], v[40:43], v[136:139]
    v_cvt_pk_bf16_f32 v160, v132, v133
    v_cvt_pk_bf16_f32 v161, v134, v135
    v_mfma_f32_16x16x32_bf16 v[136:139], a[116:119], v[44:47], v[136:139]
    v_cvt_pk_bf16_f32 v74, v92, v93
    v_cvt_pk_bf16_f32 v75, v94, v95
    v_mfma_f32_16x16x32_bf16 v[136:139], a[140:143], v[48:51], v[136:139]
    s_cmp_lg_u32 s30, 0
    s_waitcnt lgkmcnt(4)
    v_mfma_f32_16x16x32_bf16 v[136:139], a[164:167], v[52:55], v[136:139]
    v_fmac_f32 v116, s45, v140
    v_fmac_f32 v117, s45, v141
    v_mfma_f32_16x16x32_bf16 v[136:139], a[188:191], v[56:59], v[136:139]
    v_fmac_f32 v118, s45, v142
    v_fmac_f32 v119, s45, v143
    v_mfma_f32_16x16x32_bf16 v[136:139], a[212:215], v[60:63], v[136:139]
    buffer_store_dwordx4 v[164:167], v30, s[20:23], s29 offen offset:0 nt
    s_cbranch_scc1 L_cloop
    s_nop 7
    v_cvt_pk_bf16_f32 v162, v136, v137
    v_cvt_pk_bf16_f32 v163, v138, v139
    v_cndmask_b32 v168, v152, v160, vcc
    v_cndmask_b32 v169, v153, v161, vcc
    v_cndmask_b32 v170, v154, v162, vcc
    v_cndmask_b32 v171, v155, v163, vcc
    buffer_store_dwordx4 v[168:171], v30, s[20:23], s29 offen offset:128 nt
    s_not_b64 vcc, vcc
    v_cndmask_b32_dpp v160, v156, v160, vcc quad_perm:[1,0,3,2] row_mask:0xf bank_mask:0xf
    v_cndmask_b32_dpp v161, v157, v161, vcc quad_perm:[1,0,3,2] row_mask:0xf bank_mask:0xf
    v_cndmask_b32_dpp v162, v158, v162, vcc quad_perm:[1,0,3,2] row_mask:0xf bank_mask:0xf
    v_cndmask_b32_dpp v163, v159, v163, vcc quad_perm:[1,0,3,2] row_mask:0xf bank_mask:0xf
    buffer_store_dwordx4 v[160:163], v30, s[20:23], s29 offen offset:256 nt
    s_waitcnt vmcnt(5)
    s_endpgm
L_prod:
    s_mul_i32 s46, s52, 7168
    s_cmp_lt_i32 s34, 0
    s_cselect_b32 s50, 0, s14
    s_cselect_b32 s37, 0, s27
    s_mov_b32 s51, 0x20000
    s_waitcnt lgkmcnt(0)
    s_mov_b32 s12, s4
    s_and_b32 s13, s5, 0xffff
    s_mov_b32 s48, s4
    s_and_b32 s49, s5, 0xffff
    v_mov_b32 v9, 0x40000000
    v_mul_u32_u24 v3, 2731, v1
    v_lshrrev_b32 v3, 16, v3
    v_mul_u32_u24 v4, 24, v3
    v_add_u32 v5, 7, v3
    v_sub_u32 v4, v1, v4
    v_lshrrev_b32 v5, 4, v5
    v_mul_u32_u24 v6, 9, v5
    v_sub_u32 v6, v3, v6
    v_lshl_add_u32 v7, v6, 1, v5
    v_lshlrev_b32 v6, 4, v6
    v_and_b32 v6, 32, v6
    v_lshlrev_b32 v4, 4, v4
    v_xor_b32 v4, v4, v6
    v_lshl_add_u32 v5, v7, 1, s36
    v_mul_u32_u24 v7, 384, v7
    v_cmp_gt_u32 vcc, 0x200, v5
    v_add3_u32 v4, v4, v7, s47
    s_nop 0
    v_cndmask_b32 v22, v9, v4, vcc
    v_add_u32 v2, 64, v1
    v_mul_u32_u24 v3, 2731, v2
    v_lshrrev_b32 v3, 16, v3
    v_mul_u32_u24 v4, 24, v3
    v_add_u32 v5, 7, v3
    v_sub_u32 v4, v2, v4
    v_lshrrev_b32 v5, 4, v5
    v_mul_u32_u24 v6, 9, v5
    v_sub_u32 v6, v3, v6
    v_lshl_add_u32 v7, v6, 1, v5
    v_lshlrev_b32 v6, 4, v6
    v_and_b32 v6, 32, v6
    v_lshlrev_b32 v4, 4, v4
    v_xor_b32 v4, v4, v6
    v_lshl_add_u32 v5, v7, 1, s36
    v_mul_u32_u24 v7, 384, v7
    v_cmp_gt_u32 vcc, 0x200, v5
    v_add3_u32 v4, v4, v7, s47
    v_subrev_u32 v4, 1024, v4
    s_nop 0
    v_cndmask_b32 v23, v9, v4, vcc
    v_add_u32 v2, 128, v1
    v_mul_u32_u24 v3, 2731, v2
    v_lshrrev_b32 v3, 16, v3
    v_mul_u32_u24 v4, 24, v3
    v_add_u32 v5, 7, v3
    v_sub_u32 v4, v2, v4
    v_lshrrev_b32 v5, 4, v5
    v_mul_u32_u24 v6, 9, v5
    v_sub_u32 v6, v3, v6
    v_lshl_add_u32 v7, v6, 1, v5
    v_lshlrev_b32 v6, 4, v6
    v_and_b32 v6, 32, v6
    v_lshlrev_b32 v4, 4, v4
    v_xor_b32 v4, v4, v6
    v_lshl_add_u32 v5, v7, 1, s36
    v_mul_u32_u24 v7, 384, v7
    v_cmp_gt_u32 vcc, 0x200, v5
    v_add3_u32 v4, v4, v7, s47
    v_subrev_u32 v4, 2048, v4
    s_nop 0
    v_cndmask_b32 v24, v9, v4, vcc
    v_add_u32 v2, 192, v1
    v_mul_u32_u24 v3, 2731, v2
    v_lshrrev_b32 v3, 16, v3
    v_mul_u32_u24 v4, 24, v3
    v_add_u32 v5, 7, v3
    v_sub_u32 v4, v2, v4
    v_lshrrev_b32 v5, 4, v5
    v_mul_u32_u24 v6, 9, v5
    v_sub_u32 v6, v3, v6
    v_lshl_add_u32 v7, v6, 1, v5
    v_lshlrev_b32 v6, 4, v6
    v_and_b32 v6, 32, v6
    v_lshlrev_b32 v4, 4, v4
    v_xor_b32 v4, v4, v6
    v_lshl_add_u32 v5, v7, 1, s36
    v_mul_u32_u24 v7, 384, v7
    v_cmp_gt_u32 vcc, 0x200, v5
    v_add3_u32 v4, v4, v7, s47
    s_nop 0
    v_cndmask_b32 v25, v9, v4, vcc
    v_add_u32 v2, 256, v1
    v_mul_u32_u24 v3, 2731, v2
    v_lshrrev_b32 v3, 16, v3
    v_mul_u32_u24 v4, 24, v3
    v_add_u32 v5, 7, v3
    v_sub_u32 v4, v2, v4
    v_lshrrev_b32 v5, 4, v5
    v_mul_u32_u24 v6, 9, v5
    v_sub_u32 v6, v3, v6
    v_lshl_add_u32 v7, v6, 1, v5
    v_lshlrev_b32 v6, 4, v6
    v_and_b32 v6, 32, v6
    v_lshlrev_b32 v4, 4, v4
    v_xor_b32 v4, v4, v6
    v_lshl_add_u32 v5, v7, 1, s36
    v_mul_u32_u24 v7, 384, v7
    v_cmp_gt_u32 vcc, 0x200, v5
    v_add3_u32 v4, v4, v7, s47
    v_subrev_u32 v4, 1024, v4
    s_nop 0
    v_cndmask_b32 v26, v9, v4, vcc
    v_add_u32 v2, 320, v1
    v_mul_u32_u24 v3, 2731, v2
    v_lshrrev_b32 v3, 16, v3
    v_mul_u32_u24 v4, 24, v3
    v_add_u32 v5, 7, v3
    v_sub_u32 v4, v2, v4
    v_lshrrev_b32 v5, 4, v5
    v_mul_u32_u24 v6, 9, v5
    v_sub_u32 v6, v3, v6
    v_lshl_add_u32 v7, v6, 1, v5
    v_lshlrev_b32 v6, 4, v6
    v_and_b32 v6, 32, v6
    v_lshlrev_b32 v4, 4, v4
    v_xor_b32 v4, v4, v6
    v_lshl_add_u32 v5, v7, 1, s36
    v_mul_u32_u24 v7, 384, v7
    v_cmp_gt_u32 vcc, 0x200, v5
    v_add3_u32 v4, v4, v7, s47
    v_subrev_u32 v4, 2048, v4
    s_nop 0
    v_cndmask_b32 v27, v9, v4, vcc
    v_add_u32 v2, 384, v1
    v_mul_u32_u24 v3, 2731, v2
    v_lshrrev_b32 v3, 16, v3
    v_mul_u32_u24 v4, 24, v3
    v_add_u32 v5, 7, v3
    v_sub_u32 v4, v2, v4
    v_lshrrev_b32 v5, 4, v5
    v_mul_u32_u24 v6, 9, v5
    v_sub_u32 v6, v3, v6
    v_lshl_add_u32 v7, v6, 1, v5
    v_lshlrev_b32 v6, 4, v6
    v_and_b32 v6, 32, v6
    v_lshlrev_b32 v4, 4, v4
    v_xor_b32 v4, v4, v6
    v_lshl_add_u32 v5, v7, 1, s36
    v_mul_u32_u24 v7, 384, v7
    v_cmp_gt_u32 vcc, 0x200, v5
    v_add3_u32 v4, v4, v7, s47
    v_subrev_u32 v4, 3072, v4
    v_cmp_gt_u32 s[56:57], 48, v1
    s_nop 1
    s_and_b64 vcc, vcc, s[56:57]
    s_nop 0
    v_cndmask_b32 v28, v9, v4, vcc
    s_add_u32 m0, s46, 135168
    s_nop 0
    buffer_load_dwordx4 v22, s[48:51], s37 offen offset:0 lds
    buffer_load_dwordx4 v23, s[48:51], s37 offen offset:1024 lds
    buffer_load_dwordx4 v24, s[48:51], s37 offen offset:2048 lds
    s_addk_i32 m0, 0xc00
    s_nop 0
    buffer_load_dwordx4 v25, s[48:51], s37 offen offset:0 lds
    buffer_load_dwordx4 v26, s[48:51], s37 offen offset:1024 lds
    buffer_load_dwordx4 v27, s[48:51], s37 offen offset:2048 lds
    buffer_load_dwordx4 v28, s[48:51], s37 offen offset:3072 lds
    s_add_u32 s27, s27, 393216
    s_lshl_b32 s53, s52, 15
    s_or_b32 s53, s53, 0x3f00
    s_mov_b32 s54, 0x3f00
    s_or_b32 s45, s53, 0x80
    s_mov_b32 s38, 0x3f80
    v_lshrrev_b32 v2, 3, v1
    v_lshrrev_b32 v3, 2, v1
    v_and_b32 v3, 1, v3
    v_mul_u32_u24 v3, 192, v3
    v_and_b32 v4, 3, v1
    v_lshl_add_u32 v3, v4, 3, v3
    s_cmp_lg_u32 s24, 0
    s_cselect_b32 s34, 3456, 0
    s_cmp_eq_u32 s24, 3
    s_cselect_b32 s35, 3456, 0
    v_mul_u32_u24 v4, 384, v2
    v_lshlrev_b32 v5, 4, v2
    v_and_b32 v5, 32, v5
    v_add3_u32 v4, v4, v3, s34
    v_add_u32 v14, v4, v5
    v_xor_b32 v5, 32, v5
    v_add_u32 v15, v4, v5
    v_add_u32 v10, 135168, v14
    v_add_u32 v11, 135168, v15
    v_add_u32 v2, 1, v2
    v_mul_u32_u24 v4, 384, v2
    v_lshlrev_b32 v5, 4, v2
    v_and_b32 v5, 32, v5
    v_add3_u32 v4, v4, v3, s35
    v_add_u32 v16, v4, v5
    v_xor_b32 v5, 32, v5
    v_add_u32 v17, v4, v5
    v_add_u32 v12, 135168, v16
    v_add_u32 v13, 135168, v17
    v_lshrrev_b32 v2, 2, v1
    v_mul_u32_u24 v2, 192, v2
    v_and_b32 v3, 3, v1
    v_lshlrev_b32 v3, 4, v3
    s_mul_i32 s34, s52, 8
    v_add3_u32 v18, v2, v3, s34
    v_add_u32 v20, 55296, v18
    v_lshrrev_b32 v2, 4, v1
    v_bfe_u32 v3, v1, 2, 2
    v_cmp_eq_u32 vcc, v2, v3
    v_bfe_i32 v8, v1, 1, 1
    v_lshlrev_b32 v5, 4, v1
    v_cndmask_b32 v2, 0, -1, vcc
    v_and_b32 v5, 16, v5
    v_not_b32 v7, v8
    v_and_b32 v7, v7, v2
    v_and_b32 v8, v8, v2
    v_lshlrev_b32 v6, v5, s53
    v_and_b32 v36, v6, v7
    v_and_b32 v37, v6, v8
    v_lshlrev_b32 v6, v5, s54
    v_and_b32 v38, v6, v7
    v_and_b32 v39, v6, v8
    s_mov_b32 s31, 135168
    s_mov_b32 s32, 55296
    s_mov_b32 s33, 83968
    s_mov_b32 s55, 24576
    s_mov_b32 s30, 8
    v_lshlrev_b32 v6, v5, s38
    v_and_b32 v128, v6, v7
    v_and_b32 v129, v6, v8
    v_mov_b32 v130, v128
    v_mov_b32 v131, v129
    v_lshlrev_b32 v6, v5, s45
    v_and_b32 v134, v6, v7
    v_and_b32 v135, v6, v8
    s_xor_b32 s45, s45, 0x8000
    v_lshlrev_b32 v6, v5, s45
    v_and_b32 v140, v6, v7
    v_and_b32 v141, v6, v8
    v_mov_b32 v132, 0
    v_mov_b32 v138, 0
    v_mov_b32 v133, 0
    v_mov_b32 v139, 0
    v_mov_b32 v136, 0
    v_mov_b32 v142, 0
    v_mov_b32 v137, 0
    v_mov_b32 v143, 0
    v_lshlrev_b32 v2, 4, v1
    s_mul_i32 s35, s52, 7168
    s_add_u32 s35, s35, 0
    v_add_u32 v29, s35, v2
    s_mul_i32 s35, s52, 5120
    s_add_u32 s35, s35, 1024
    v_add_u32 v31, s35, v2
    s_mul_i32 s35, s52, 3072
    s_add_u32 s36, s35, 112640
    v_add_u32 v32, s36, v2
    s_sub_u32 s36, 115712, s35
    v_add_u32 v33, s36, v2
    s_waitcnt lgkmcnt(0)
    s_barrier
    ds_read_b64_tr_b16 a[132:133], v18 offset:0
    ds_read_b64_tr_b16 a[134:135], v18 offset:12288
    ds_read_b64_tr_b16 a[136:137], v18 offset:3072
    ds_read_b64_tr_b16 a[138:139], v18 offset:15360
    ds_read_b64_tr_b16 a[140:141], v18 offset:6144
    ds_read_b64_tr_b16 a[142:143], v18 offset:9216
    ds_read_b64_tr_b16 a[144:145], v18 offset:64
    ds_read_b64_tr_b16 a[146:147], v18 offset:12352
    ds_read_b64_tr_b16 a[148:149], v18 offset:3136
    ds_read_b64_tr_b16 a[150:151], v18 offset:15424
    ds_read_b64_tr_b16 a[152:153], v18 offset:6208
    ds_read_b64_tr_b16 a[154:155], v18 offset:9280
    s_waitcnt lgkmcnt(8)
    v_mfma_f32_16x16x32_bf16 v[88:91], v[128:131], a[132:135], 0
    ds_read_b64_tr_b16 a[156:157], v18 offset:128
    ds_read_b64_tr_b16 a[158:159], v18 offset:12416
    v_mfma_f32_16x16x32_bf16 v[92:95], v[128:131], a[136:139], 0
    ds_read_b64_tr_b16 a[160:161], v18 offset:3200
    ds_read_b64_tr_b16 a[162:163], v18 offset:15488
    s_waitcnt lgkmcnt(10)
    v_mfma_f32_16x16x32_bf16 v[96:99], v[140:143], a[140:143], v[88:91]
    ds_read_b64_tr_b16 a[164:165], v18 offset:6272
    ds_read_b64_tr_b16 a[166:167], v18 offset:9344
    v_mfma_f32_16x16x32_bf16 v[100:103], v[138:141], a[140:143], v[92:95]
    v_mfma_f32_16x16x32_bf16 v[88:91], v[134:137], a[140:143], v[88:91]
    v_mfma_f32_16x16x32_bf16 v[92:95], v[132:135], a[140:143], v[92:95]
    s_waitcnt lgkmcnt(0)
    s_barrier
    v_mfma_f32_16x16x32_bf16 v[104:107], v[128:131], a[144:147], 0
    ds_read_b64_tr_b16 a[132:133], v18 offset:18432
    ds_read_b64_tr_b16 a[134:135], v18 offset:30720
    v_mfma_f32_16x16x32_bf16 v[108:111], v[128:131], a[148:151], 0
    ds_read_b64_tr_b16 a[136:137], v18 offset:21504
    ds_read_b64_tr_b16 a[138:139], v18 offset:33792
    v_mfma_f32_16x16x32_bf16 v[112:115], v[140:143], a[152:155], v[104:107]
    ds_read_b64_tr_b16 a[140:141], v18 offset:24576
    ds_read_b64_tr_b16 a[142:143], v18 offset:27648
    v_cvt_pk_bf16_f32 v120, v96, v97
    v_cvt_pk_bf16_f32 v121, v98, v99
    v_mfma_f32_16x16x32_bf16 v[116:119], v[138:141], a[152:155], v[108:111]
    v_cvt_pk_bf16_f32 v122, v100, v101
    v_cvt_pk_bf16_f32 v123, v102, v103
    v_mfma_f32_16x16x32_bf16 v[104:107], v[134:137], a[152:155], v[104:107]
    ds_write_b128 v32, v[120:123] offset:0
    v_cvt_pk_bf16_f32 v148, v88, v89
    v_cvt_pk_bf16_f32 v149, v90, v91
    v_mfma_f32_16x16x32_bf16 v[108:111], v[132:135], a[152:155], v[108:111]
    v_cvt_pk_bf16_f32 v150, v92, v93
    v_cvt_pk_bf16_f32 v151, v94, v95
    v_mfma_f32_16x16x32_bf16 v[88:91], v[128:131], a[156:159], 0
    ds_read_b64_tr_b16 a[144:145], v18 offset:18496
    ds_read_b64_tr_b16 a[146:147], v18 offset:30784
    v_mfma_f32_16x16x32_bf16 v[92:95], v[128:131], a[160:163], 0
    ds_read_b64_tr_b16 a[148:149], v18 offset:21568
    ds_read_b64_tr_b16 a[150:151], v18 offset:33856
    v_mfma_f32_16x16x32_bf16 v[96:99], v[140:143], a[164:167], v[88:91]
    ds_read_b64_tr_b16 a[152:153], v18 offset:24640
    ds_read_b64_tr_b16 a[154:155], v18 offset:27712
    v_cvt_pk_bf16_f32 v124, v112, v113
    v_cvt_pk_bf16_f32 v125, v114, v115
    v_mfma_f32_16x16x32_bf16 v[100:103], v[138:141], a[164:167], v[92:95]
    v_cvt_pk_bf16_f32 v126, v116, v117
    v_cvt_pk_bf16_f32 v127, v118, v119
    v_mfma_f32_16x16x32_bf16 v[88:91], v[134:137], a[164:167], v[88:91]
    ds_write_b128 v32, v[124:127] offset:1024
    v_cvt_pk_bf16_f32 v152, v104, v105
    v_cvt_pk_bf16_f32 v153, v106, v107
    v_mfma_f32_16x16x32_bf16 v[92:95], v[132:135], a[164:167], v[92:95]
    v_cvt_pk_bf16_f32 v154, v108, v109
    v_cvt_pk_bf16_f32 v155, v110, v111
    s_waitcnt lgkmcnt(10)
    v_mfma_f32_16x16x32_bf16 v[104:107], v[128:131], a[132:135], 0
    ds_read_b64_tr_b16 a[156:157], v18 offset:18560
    ds_read_b64_tr_b16 a[158:159], v18 offset:30848
    v_mfma_f32_16x16x32_bf16 v[108:111], v[128:131], a[136:139], 0
    ds_read_b64_tr_b16 a[160:161], v18 offset:21632
    ds_read_b64_tr_b16 a[162:163], v18 offset:33920
    s_waitcnt lgkmcnt(12)
    v_mfma_f32_16x16x32_bf16 v[112:115], v[140:143], a[140:143], v[104:107]
    ds_read_b64_tr_b16 a[164:165], v18 offset:24704
    ds_read_b64_tr_b16 a[166:167], v18 offset:27776
    v_cvt_pk_bf16_f32 v120, v96, v97
    v_cvt_pk_bf16_f32 v121, v98, v99
    v_mfma_f32_16x16x32_bf16 v[116:119], v[138:141], a[140:143], v[108:111]
    v_cvt_pk_bf16_f32 v122, v100, v101
    v_cvt_pk_bf16_f32 v123, v102, v103
    v_mfma_f32_16x16x32_bf16 v[104:107], v[134:137], a[140:143], v[104:107]
    ds_write_b128 v32, v[120:123] offset:2048
    v_cvt_pk_bf16_f32 v156, v88, v89
    v_cvt_pk_bf16_f32 v157, v90, v91
    v_mfma_f32_16x16x32_bf16 v[108:111], v[132:135], a[140:143], v[108:111]
    v_cvt_pk_bf16_f32 v158, v92, v93
    v_cvt_pk_bf16_f32 v159, v94, v95
    s_add_u32 m0, s46, 149504
    s_nop 0
    buffer_load_dwordx4 v22, s[12:15], s27 offen offset:0 lds
    buffer_load_dwordx4 v23, s[12:15], s27 offen offset:1024 lds
    buffer_load_dwordx4 v24, s[12:15], s27 offen offset:2048 lds
    s_addk_i32 m0, 0xc00
    s_nop 0
    buffer_load_dwordx4 v25, s[12:15], s27 offen offset:0 lds
    buffer_load_dwordx4 v26, s[12:15], s27 offen offset:1024 lds
    buffer_load_dwordx4 v27, s[12:15], s27 offen offset:2048 lds
    buffer_load_dwordx4 v28, s[12:15], s27 offen offset:3072 lds
    s_add_u32 s27, s27, 393216
    s_waitcnt vmcnt(7) lgkmcnt(1)
    s_barrier
    v_mfma_f32_16x16x32_bf16 v[88:91], v[128:131], a[144:147], 0
    ds_read_b64_tr_b16 a[132:133], v18 offset:36864
    ds_read_b64_tr_b16 a[134:135], v18 offset:49152
    v_mfma_f32_16x16x32_bf16 v[92:95], v[128:131], a[148:151], 0
    ds_read_b64_tr_b16 a[136:137], v18 offset:39936
    ds_read_b64_tr_b16 a[138:139], v18 offset:52224
    v_mfma_f32_16x16x32_bf16 v[96:99], v[140:143], a[152:155], v[88:91]
    ds_read_b64_tr_b16 a[140:141], v18 offset:43008
    ds_read_b64_tr_b16 a[142:143], v18 offset:46080
    v_cvt_pk_bf16_f32 v124, v112, v113
    v_cvt_pk_bf16_f32 v125, v114, v115
    v_mfma_f32_16x16x32_bf16 v[100:103], v[138:141], a[152:155], v[92:95]
    v_cvt_pk_bf16_f32 v126, v116, v117
    v_cvt_pk_bf16_f32 v127, v118, v119
    v_mfma_f32_16x16x32_bf16 v[88:91], v[134:137], a[152:155], v[88:91]
    ds_write_b128 v32, v[124:127] offset:6144
    v_cvt_pk_bf16_f32 v160, v104, v105
    v_cvt_pk_bf16_f32 v161, v106, v107
    v_mfma_f32_16x16x32_bf16 v[92:95], v[132:135], a[152:155], v[92:95]
    v_cvt_pk_bf16_f32 v162, v108, v109
    v_cvt_pk_bf16_f32 v163, v110, v111
    v_mfma_f32_16x16x32_bf16 v[104:107], v[128:131], a[156:159], 0
    ds_read_b64_tr_b16 a[144:145], v18 offset:36928
    ds_read_b64_tr_b16 a[146:147], v18 offset:49216
    v_mfma_f32_16x16x32_bf16 v[108:111], v[128:131], a[160:163], 0
    ds_read_b64_tr_b16 a[148:149], v18 offset:40000
    ds_read_b64_tr_b16 a[150:151], v18 offset:52288
    v_mfma_f32_16x16x32_bf16 v[112:115], v[140:143], a[164:167], v[104:107]
    ds_read_b64_tr_b16 a[152:153], v18 offset:43072
    ds_read_b64_tr_b16 a[154:155], v18 offset:46144
    v_cvt_pk_bf16_f32 v120, v96, v97
    v_cvt_pk_bf16_f32 v121, v98, v99
    v_mfma_f32_16x16x32_bf16 v[116:119], v[138:141], a[164:167], v[108:111]
    ds_read_b64_tr_b16 a[168:169], v10 offset:0
    ds_read_b64_tr_b16 a[170:171], v12 offset:0
    v_cvt_pk_bf16_f32 v122, v100, v101
    v_cvt_pk_bf16_f32 v123, v102, v103
    v_mfma_f32_16x16x32_bf16 v[104:107], v[134:137], a[164:167], v[104:107]
    ds_write_b128 v32, v[120:123] offset:7168
    ds_read_b64_tr_b16 a[172:173], v11 offset:0
    ds_read_b64_tr_b16 a[174:175], v13 offset:0
    v_cvt_pk_bf16_f32 v164, v88, v89
    v_cvt_pk_bf16_f32 v165, v90, v91
    v_mfma_f32_16x16x32_bf16 v[108:111], v[132:135], a[164:167], v[108:111]
    ds_read_b64_tr_b16 a[176:177], v10 offset:64
    ds_read_b64_tr_b16 a[178:179], v12 offset:64
    v_cvt_pk_bf16_f32 v166, v92, v93
    v_cvt_pk_bf16_f32 v167, v94, v95
    s_waitcnt lgkmcnt(15)
    v_mfma_f32_16x16x32_bf16 v[88:91], v[128:131], a[132:135], 0
    ds_read_b64_tr_b16 a[156:157], v18 offset:36992
    ds_read_b64_tr_b16 a[158:159], v18 offset:49280
    v_mfma_f32_16x16x32_bf16 v[92:95], v[128:131], a[136:139], 0
    ds_read_b64_tr_b16 a[160:161], v18 offset:40064
    ds_read_b64_tr_b16 a[162:163], v18 offset:52352
    s_waitcnt lgkmcnt(15)
    v_mfma_f32_16x16x32_bf16 v[96:99], v[140:143], a[140:143], v[88:91]
    ds_read_b64_tr_b16 a[164:165], v18 offset:43136
    ds_read_b64_tr_b16 a[166:167], v18 offset:46208
    v_cvt_pk_bf16_f32 v124, v112, v113
    v_cvt_pk_bf16_f32 v125, v114, v115
    v_mfma_f32_16x16x32_bf16 v[100:103], v[138:141], a[140:143], v[92:95]
    ds_read_b64_tr_b16 a[180:181], v11 offset:64
    ds_read_b64_tr_b16 a[182:183], v13 offset:64
    v_cvt_pk_bf16_f32 v126, v116, v117
    v_cvt_pk_bf16_f32 v127, v118, v119
    v_mfma_f32_16x16x32_bf16 v[88:91], v[134:137], a[140:143], v[88:91]
    ds_write_b128 v32, v[124:127] offset:8192
    ds_read_b64_tr_b16 a[184:185], v10 offset:128
    ds_read_b64_tr_b16 a[186:187], v12 offset:128
    v_cvt_pk_bf16_f32 v168, v104, v105
    v_cvt_pk_bf16_f32 v169, v106, v107
    v_mfma_f32_16x16x32_bf16 v[92:95], v[132:135], a[140:143], v[92:95]
    ds_read_b64_tr_b16 a[188:189], v11 offset:128
    ds_read_b64_tr_b16 a[190:191], v13 offset:128
    v_cvt_pk_bf16_f32 v170, v108, v109
    v_cvt_pk_bf16_f32 v171, v110, v111
    s_waitcnt vmcnt(7) lgkmcnt(7)
    s_barrier
    v_mfma_f32_16x16x32_bf16 v[104:107], v[128:131], a[144:147], 0
    ds_read_b64_tr_b16 a[132:133], v20 offset:0
    ds_read_b64_tr_b16 a[134:135], v20 offset:12288
    v_mfma_f32_16x16x32_bf16 v[108:111], v[128:131], a[148:151], 0
    ds_read_b64_tr_b16 a[136:137], v20 offset:3072
    ds_read_b64_tr_b16 a[138:139], v20 offset:15360
    v_mfma_f32_16x16x32_bf16 v[112:115], v[140:143], a[152:155], v[104:107]
    ds_read_b64_tr_b16 a[140:141], v20 offset:6144
    ds_read_b64_tr_b16 a[142:143], v20 offset:9216
    v_cvt_pk_bf16_f32 v120, v96, v97
    v_cvt_pk_bf16_f32 v121, v98, v99
    v_mfma_f32_16x16x32_bf16 v[116:119], v[138:141], a[152:155], v[108:111]
    v_cvt_pk_bf16_f32 v122, v100, v101
    v_cvt_pk_bf16_f32 v123, v102, v103
    v_mfma_f32_16x16x32_bf16 v[104:107], v[134:137], a[152:155], v[104:107]
    ds_write_b128 v32, v[120:123] offset:12288
    ds_read_b128 a[0:3], v33 offset:0
    v_cvt_pk_bf16_f32 v172, v88, v89
    v_cvt_pk_bf16_f32 v173, v90, v91
    v_mfma_f32_16x16x32_bf16 v[108:111], v[132:135], a[152:155], v[108:111]
    ds_read_b128 a[4:7], v33 offset:1024
    v_cvt_pk_bf16_f32 v174, v92, v93
    v_cvt_pk_bf16_f32 v175, v94, v95
    s_waitcnt lgkmcnt(9)
    v_mfma_f32_16x16x32_bf16 v[76:79], a[168:171], v[36:39], 0
    v_mfma_f32_16x16x32_bf16 v[80:83], a[172:175], v[36:39], 0
    v_mfma_f32_16x16x32_bf16 v[84:87], a[176:179], v[36:39], 0
    v_mfma_f32_16x16x32_bf16 v[144:147], a[180:183], v[36:39], 0
    v_mfma_f32_16x16x32_bf16 v[2:5], a[184:187], v[36:39], 0
    v_mfma_f32_16x16x32_bf16 v[6:9], a[188:191], v[36:39], 0
    v_mfma_f32_16x16x32_bf16 v[88:91], v[128:131], a[156:159], 0
    ds_read_b64_tr_b16 a[144:145], v20 offset:64
    ds_read_b64_tr_b16 a[146:147], v20 offset:12352
    v_cvt_pk_bf16_f32 v40, v76, v77
    v_cvt_pk_bf16_f32 v41, v78, v79
    v_mfma_f32_16x16x32_bf16 v[92:95], v[128:131], a[160:163], 0
    ds_read_b64_tr_b16 a[148:149], v20 offset:3136
    ds_read_b64_tr_b16 a[150:151], v20 offset:15424
    v_cvt_pk_bf16_f32 v42, v80, v81
    v_cvt_pk_bf16_f32 v43, v82, v83
    v_mfma_f32_16x16x32_bf16 v[96:99], v[140:143], a[164:167], v[88:91]
    ds_read_b64_tr_b16 a[152:153], v20 offset:6208
    ds_read_b64_tr_b16 a[154:155], v20 offset:9280
    v_cvt_pk_bf16_f32 v124, v112, v113
    v_cvt_pk_bf16_f32 v125, v114, v115
    v_cvt_pk_bf16_f32 v44, v84, v85
    v_cvt_pk_bf16_f32 v45, v86, v87
    v_mfma_f32_16x16x32_bf16 v[100:103], v[138:141], a[164:167], v[92:95]
    ds_read_b128 a[8:11], v33 offset:2048
    ds_read_b64_tr_b16 a[168:169], v10 offset:7168
    v_cvt_pk_bf16_f32 v126, v116, v117
    v_cvt_pk_bf16_f32 v127, v118, v119
    v_cvt_pk_bf16_f32 v46, v144, v145
    v_cvt_pk_bf16_f32 v47, v146, v147
    v_mfma_f32_16x16x32_bf16 v[88:91], v[134:137], a[164:167], v[88:91]
    ds_write_b128 v32, v[124:127] offset:13312
    ds_read_b64_tr_b16 a[170:171], v12 offset:7168
    ds_read_b64_tr_b16 a[172:173], v11 offset:7168
    v_cvt_pk_bf16_f32 v176, v104, v105
    v_cvt_pk_bf16_f32 v177, v106, v107
    v_cvt_pk_bf16_f32 v48, v2, v3
    v_cvt_pk_bf16_f32 v49, v4, v5
    v_mfma_f32_16x16x32_bf16 v[92:95], v[132:135], a[164:167], v[92:95]
    ds_read_b64_tr_b16 a[174:175], v13 offset:7168
    ds_read_b64_tr_b16 a[176:177], v10 offset:7232
    ds_read_b64_tr_b16 a[178:179], v12 offset:7232
    v_cvt_pk_bf16_f32 v178, v108, v109
    v_cvt_pk_bf16_f32 v179, v110, v111
    v_cvt_pk_bf16_f32 v50, v6, v7
    v_cvt_pk_bf16_f32 v51, v8, v9
    s_waitcnt lgkmcnt(15)
    v_mfma_f32_16x16x32_bf16 v[104:107], v[128:131], a[132:135], 0
    ds_read_b64_tr_b16 a[156:157], v20 offset:128
    ds_read_b64_tr_b16 a[158:159], v20 offset:12416
    v_mfma_f32_16x16x32_bf16 v[108:111], v[128:131], a[136:139], 0
    ds_read_b64_tr_b16 a[160:161], v20 offset:3200
    ds_read_b64_tr_b16 a[162:163], v20 offset:15488
    s_waitcnt lgkmcnt(15)
    v_mfma_f32_16x16x32_bf16 v[112:115], v[140:143], a[140:143], v[104:107]
    ds_read_b64_tr_b16 a[164:165], v20 offset:6272
    ds_read_b64_tr_b16 a[166:167], v20 offset:9344
    v_cvt_pk_bf16_f32 v120, v96, v97
    v_cvt_pk_bf16_f32 v121, v98, v99
    v_mfma_f32_16x16x32_bf16 v[116:119], v[138:141], a[140:143], v[108:111]
    ds_read_b64_tr_b16 a[180:181], v11 offset:7232
    ds_read_b64_tr_b16 a[182:183], v13 offset:7232
    v_cvt_pk_bf16_f32 v122, v100, v101
    v_cvt_pk_bf16_f32 v123, v102, v103
    v_mfma_f32_16x16x32_bf16 v[104:107], v[134:137], a[140:143], v[104:107]
    ds_write_b128 v32, v[120:123] offset:14336
    ds_read_b64_tr_b16 a[184:185], v10 offset:7296
    ds_read_b64_tr_b16 a[186:187], v12 offset:7296
    v_cvt_pk_bf16_f32 v180, v88, v89
    v_cvt_pk_bf16_f32 v181, v90, v91
    v_mfma_f32_16x16x32_bf16 v[108:111], v[132:135], a[140:143], v[108:111]
    ds_read_b64_tr_b16 a[188:189], v11 offset:7296
    ds_read_b64_tr_b16 a[190:191], v13 offset:7296
    v_cvt_pk_bf16_f32 v182, v92, v93
    v_cvt_pk_bf16_f32 v183, v94, v95
    s_waitcnt lgkmcnt(7)
    s_barrier
    v_mfma_f32_16x16x32_bf16 v[88:91], v[128:131], a[144:147], 0
    ds_read_b64_tr_b16 a[132:133], v20 offset:18432
    ds_read_b64_tr_b16 a[134:135], v20 offset:30720
    v_mfma_f32_16x16x32_bf16 v[92:95], v[128:131], a[148:151], 0
    ds_read_b64_tr_b16 a[136:137], v20 offset:21504
    ds_read_b64_tr_b16 a[138:139], v20 offset:33792
    v_mfma_f32_16x16x32_bf16 v[96:99], v[140:143], a[152:155], v[88:91]
    ds_read_b64_tr_b16 a[140:141], v20 offset:24576
    ds_read_b64_tr_b16 a[142:143], v20 offset:27648
    v_cvt_pk_bf16_f32 v124, v112, v113
    v_cvt_pk_bf16_f32 v125, v114, v115
    v_mfma_f32_16x16x32_bf16 v[100:103], v[138:141], a[152:155], v[92:95]
    v_cvt_pk_bf16_f32 v126, v116, v117
    v_cvt_pk_bf16_f32 v127, v118, v119
    v_mfma_f32_16x16x32_bf16 v[88:91], v[134:137], a[152:155], v[88:91]
    ds_write_b128 v32, v[124:127] offset:0
    ds_read_b128 a[12:15], v33 offset:6144
    v_cvt_pk_bf16_f32 v184, v104, v105
    v_cvt_pk_bf16_f32 v185, v106, v107
    v_mfma_f32_16x16x32_bf16 v[92:95], v[132:135], a[152:155], v[92:95]
    ds_read_b128 a[16:19], v33 offset:7168
    v_cvt_pk_bf16_f32 v186, v108, v109
    v_cvt_pk_bf16_f32 v187, v110, v111
    s_waitcnt lgkmcnt(9)
    v_mfma_f32_16x16x32_bf16 v[76:79], a[168:171], v[36:39], 0
    v_mfma_f32_16x16x32_bf16 v[80:83], a[172:175], v[36:39], 0
    v_mfma_f32_16x16x32_bf16 v[84:87], a[176:179], v[36:39], 0
    v_mfma_f32_16x16x32_bf16 v[144:147], a[180:183], v[36:39], 0
    v_mfma_f32_16x16x32_bf16 v[2:5], a[184:187], v[36:39], 0
    v_mfma_f32_16x16x32_bf16 v[6:9], a[188:191], v[36:39], 0
    v_mfma_f32_16x16x32_bf16 v[104:107], v[128:131], a[156:159], 0
    ds_read_b64_tr_b16 a[144:145], v20 offset:18496
    ds_read_b64_tr_b16 a[146:147], v20 offset:30784
    v_cvt_pk_bf16_f32 v52, v76, v77
    v_cvt_pk_bf16_f32 v53, v78, v79
    v_mfma_f32_16x16x32_bf16 v[108:111], v[128:131], a[160:163], 0
    ds_read_b64_tr_b16 a[148:149], v20 offset:21568
    ds_read_b64_tr_b16 a[150:151], v20 offset:33856
    v_cvt_pk_bf16_f32 v54, v80, v81
    v_cvt_pk_bf16_f32 v55, v82, v83
    v_mfma_f32_16x16x32_bf16 v[112:115], v[140:143], a[164:167], v[104:107]
    ds_read_b64_tr_b16 a[152:153], v20 offset:24640
    ds_read_b64_tr_b16 a[154:155], v20 offset:27712
    v_cvt_pk_bf16_f32 v120, v96, v97
    v_cvt_pk_bf16_f32 v121, v98, v99
    v_cvt_pk_bf16_f32 v56, v84, v85
    v_cvt_pk_bf16_f32 v57, v86, v87
    v_mfma_f32_16x16x32_bf16 v[116:119], v[138:141], a[164:167], v[108:111]
    v_cvt_pk_bf16_f32 v122, v100, v101
    v_cvt_pk_bf16_f32 v123, v102, v103
    v_cvt_pk_bf16_f32 v58, v144, v145
    v_cvt_pk_bf16_f32 v59, v146, v147
    v_mfma_f32_16x16x32_bf16 v[104:107], v[134:137], a[164:167], v[104:107]
    ds_write_b128 v32, v[120:123] offset:1024
    v_cvt_pk_bf16_f32 v188, v88, v89
    v_cvt_pk_bf16_f32 v189, v90, v91
    v_cvt_pk_bf16_f32 v60, v2, v3
    v_cvt_pk_bf16_f32 v61, v4, v5
    v_mfma_f32_16x16x32_bf16 v[108:111], v[132:135], a[164:167], v[108:111]
    ds_read_b128 a[20:23], v33 offset:8192
    v_cvt_pk_bf16_f32 v190, v92, v93
    v_cvt_pk_bf16_f32 v191, v94, v95
    v_cvt_pk_bf16_f32 v62, v6, v7
    v_cvt_pk_bf16_f32 v63, v8, v9
    s_waitcnt lgkmcnt(13)
    v_mfma_f32_16x16x32_bf16 v[88:91], v[128:131], a[132:135], 0
    ds_read_b64_tr_b16 a[156:157], v20 offset:18560
    ds_read_b64_tr_b16 a[158:159], v20 offset:30848
    v_mfma_f32_16x16x32_bf16 v[92:95], v[128:131], a[136:139], 0
    ds_read_b64_tr_b16 a[160:161], v20 offset:21632
    ds_read_b64_tr_b16 a[162:163], v20 offset:33920
    s_waitcnt lgkmcnt(15)
    v_mfma_f32_16x16x32_bf16 v[96:99], v[140:143], a[140:143], v[88:91]
    ds_read_b64_tr_b16 a[164:165], v20 offset:24704
    ds_read_b64_tr_b16 a[166:167], v20 offset:27776
    v_cvt_pk_bf16_f32 v124, v112, v113
    v_cvt_pk_bf16_f32 v125, v114, v115
    v_mfma_f32_16x16x32_bf16 v[100:103], v[138:141], a[140:143], v[92:95]
    v_cvt_pk_bf16_f32 v126, v116, v117
    v_cvt_pk_bf16_f32 v127, v118, v119
    v_mfma_f32_16x16x32_bf16 v[88:91], v[134:137], a[140:143], v[88:91]
    ds_write_b128 v32, v[124:127] offset:2048
    v_cvt_pk_bf16_f32 v192, v104, v105
    v_cvt_pk_bf16_f32 v193, v106, v107
    v_mfma_f32_16x16x32_bf16 v[92:95], v[132:135], a[140:143], v[92:95]
    v_cvt_pk_bf16_f32 v194, v108, v109
    v_cvt_pk_bf16_f32 v195, v110, v111
    s_waitcnt vmcnt(0) lgkmcnt(1)
    s_barrier
    v_mfma_f32_16x16x32_bf16 v[104:107], v[128:131], a[144:147], 0
    ds_read_b64_tr_b16 a[132:133], v20 offset:36864
    ds_read_b64_tr_b16 a[134:135], v20 offset:49152
    v_mfma_f32_16x16x32_bf16 v[108:111], v[128:131], a[148:151], 0
    ds_read_b64_tr_b16 a[136:137], v20 offset:39936
    ds_read_b64_tr_b16 a[138:139], v20 offset:52224
    v_mfma_f32_16x16x32_bf16 v[112:115], v[140:143], a[152:155], v[104:107]
    ds_read_b64_tr_b16 a[140:141], v20 offset:43008
    ds_read_b64_tr_b16 a[142:143], v20 offset:46080
    v_cvt_pk_bf16_f32 v120, v96, v97
    v_cvt_pk_bf16_f32 v121, v98, v99
    v_mfma_f32_16x16x32_bf16 v[116:119], v[138:141], a[152:155], v[108:111]
    v_cvt_pk_bf16_f32 v122, v100, v101
    v_cvt_pk_bf16_f32 v123, v102, v103
    v_mfma_f32_16x16x32_bf16 v[104:107], v[134:137], a[152:155], v[104:107]
    ds_write_b128 v32, v[120:123] offset:6144
    ds_read_b128 a[24:27], v33 offset:12288
    v_cvt_pk_bf16_f32 v196, v88, v89
    v_cvt_pk_bf16_f32 v197, v90, v91
    v_mfma_f32_16x16x32_bf16 v[108:111], v[132:135], a[152:155], v[108:111]
    ds_read_b128 a[28:31], v33 offset:13312
    v_cvt_pk_bf16_f32 v198, v92, v93
    v_cvt_pk_bf16_f32 v199, v94, v95
    v_mfma_f32_16x16x32_bf16 v[88:91], v[128:131], a[156:159], 0
    ds_read_b64_tr_b16 a[144:145], v20 offset:36928
    ds_read_b64_tr_b16 a[146:147], v20 offset:49216
    v_mfma_f32_16x16x32_bf16 v[92:95], v[128:131], a[160:163], 0
    ds_read_b64_tr_b16 a[148:149], v20 offset:40000
    ds_read_b64_tr_b16 a[150:151], v20 offset:52288
    v_mfma_f32_16x16x32_bf16 v[96:99], v[140:143], a[164:167], v[88:91]
    ds_read_b64_tr_b16 a[152:153], v20 offset:43072
    ds_read_b64_tr_b16 a[154:155], v20 offset:46144
    v_cvt_pk_bf16_f32 v124, v112, v113
    v_cvt_pk_bf16_f32 v125, v114, v115
    v_mfma_f32_16x16x32_bf16 v[100:103], v[138:141], a[164:167], v[92:95]
    ds_read_b128 a[32:35], v33 offset:14336
    ds_read_b64_tr_b16 a[168:169], v10 offset:14336
    v_cvt_pk_bf16_f32 v126, v116, v117
    v_cvt_pk_bf16_f32 v127, v118, v119
    v_mfma_f32_16x16x32_bf16 v[88:91], v[134:137], a[164:167], v[88:91]
    ds_write_b128 v32, v[124:127] offset:7168
    ds_read_b64_tr_b16 a[170:171], v12 offset:14336
    ds_read_b64_tr_b16 a[172:173], v11 offset:14336
    v_cvt_pk_bf16_f32 v200, v104, v105
    v_cvt_pk_bf16_f32 v201, v106, v107
    v_mfma_f32_16x16x32_bf16 v[92:95], v[132:135], a[164:167], v[92:95]
    ds_read_b64_tr_b16 a[174:175], v13 offset:14336
    ds_read_b64_tr_b16 a[176:177], v10 offset:14400
    ds_read_b64_tr_b16 a[178:179], v12 offset:14400
    v_cvt_pk_bf16_f32 v202, v108, v109
    v_cvt_pk_bf16_f32 v203, v110, v111
    s_waitcnt lgkmcnt(15)
    v_mfma_f32_16x16x32_bf16 v[104:107], v[128:131], a[132:135], 0
    ds_read_b64_tr_b16 a[156:157], v20 offset:36992
    ds_read_b64_tr_b16 a[158:159], v20 offset:49280
    v_mfma_f32_16x16x32_bf16 v[108:111], v[128:131], a[136:139], 0
    ds_read_b64_tr_b16 a[160:161], v20 offset:40064
    ds_read_b64_tr_b16 a[162:163], v20 offset:52352
    s_waitcnt lgkmcnt(15)
    v_mfma_f32_16x16x32_bf16 v[112:115], v[140:143], a[140:143], v[104:107]
    ds_read_b64_tr_b16 a[164:165], v20 offset:43136
    ds_read_b64_tr_b16 a[166:167], v20 offset:46208
    v_cvt_pk_bf16_f32 v120, v96, v97
    v_cvt_pk_bf16_f32 v121, v98, v99
    v_mfma_f32_16x16x32_bf16 v[116:119], v[138:141], a[140:143], v[108:111]
    ds_read_b64_tr_b16 a[180:181], v11 offset:14400
    ds_read_b64_tr_b16 a[182:183], v13 offset:14400
    v_cvt_pk_bf16_f32 v122, v100, v101
    v_cvt_pk_bf16_f32 v123, v102, v103
    v_mfma_f32_16x16x32_bf16 v[104:107], v[134:137], a[140:143], v[104:107]
    ds_write_b128 v32, v[120:123] offset:8192
    ds_read_b64_tr_b16 a[184:185], v10 offset:14464
    ds_read_b64_tr_b16 a[186:187], v12 offset:14464
    v_cvt_pk_bf16_f32 v204, v88, v89
    v_cvt_pk_bf16_f32 v205, v90, v91
    v_mfma_f32_16x16x32_bf16 v[108:111], v[132:135], a[140:143], v[108:111]
    ds_read_b64_tr_b16 a[188:189], v11 offset:14464
    ds_read_b64_tr_b16 a[190:191], v13 offset:14464
    v_cvt_pk_bf16_f32 v206, v92, v93
    v_cvt_pk_bf16_f32 v207, v94, v95
    s_waitcnt lgkmcnt(7)
    s_barrier
    v_mfma_f32_16x16x32_bf16 v[88:91], v[128:131], a[144:147], 0
    ds_read_b64_tr_b16 a[132:133], v18 offset:0
    ds_read_b64_tr_b16 a[134:135], v18 offset:12288
    v_mfma_f32_16x16x32_bf16 v[92:95], v[128:131], a[148:151], 0
    ds_read_b64_tr_b16 a[136:137], v18 offset:3072
    ds_read_b64_tr_b16 a[138:139], v18 offset:15360
    v_mfma_f32_16x16x32_bf16 v[96:99], v[140:143], a[152:155], v[88:91]
    ds_read_b64_tr_b16 a[140:141], v18 offset:6144
    ds_read_b64_tr_b16 a[142:143], v18 offset:9216
    v_cvt_pk_bf16_f32 v124, v112, v113
    v_cvt_pk_bf16_f32 v125, v114, v115
    v_mfma_f32_16x16x32_bf16 v[100:103], v[138:141], a[152:155], v[92:95]
    v_cvt_pk_bf16_f32 v126, v116, v117
    v_cvt_pk_bf16_f32 v127, v118, v119
    v_mfma_f32_16x16x32_bf16 v[88:91], v[134:137], a[152:155], v[88:91]
    ds_write_b128 v32, v[124:127] offset:12288
    ds_read_b128 a[36:39], v33 offset:0
    v_cvt_pk_bf16_f32 v208, v104, v105
    v_cvt_pk_bf16_f32 v209, v106, v107
    v_mfma_f32_16x16x32_bf16 v[92:95], v[132:135], a[152:155], v[92:95]
    ds_read_b128 a[40:43], v33 offset:1024
    v_cvt_pk_bf16_f32 v210, v108, v109
    v_cvt_pk_bf16_f32 v211, v110, v111
    s_waitcnt lgkmcnt(9)
    v_mfma_f32_16x16x32_bf16 v[76:79], a[168:171], v[36:39], 0
    v_mfma_f32_16x16x32_bf16 v[80:83], a[172:175], v[36:39], 0
    v_mfma_f32_16x16x32_bf16 v[84:87], a[176:179], v[36:39], 0
    v_mfma_f32_16x16x32_bf16 v[144:147], a[180:183], v[36:39], 0
    v_mfma_f32_16x16x32_bf16 v[2:5], a[184:187], v[36:39], 0
    v_mfma_f32_16x16x32_bf16 v[6:9], a[188:191], v[36:39], 0
    v_mfma_f32_16x16x32_bf16 v[104:107], v[128:131], a[156:159], 0
    ds_read_b64_tr_b16 a[144:145], v18 offset:64
    ds_read_b64_tr_b16 a[146:147], v18 offset:12352
    v_cvt_pk_bf16_f32 v64, v76, v77
    v_cvt_pk_bf16_f32 v65, v78, v79
    v_mfma_f32_16x16x32_bf16 v[108:111], v[128:131], a[160:163], 0
    ds_read_b64_tr_b16 a[148:149], v18 offset:3136
    ds_read_b64_tr_b16 a[150:151], v18 offset:15424
    v_cvt_pk_bf16_f32 v66, v80, v81
    v_cvt_pk_bf16_f32 v67, v82, v83
    v_mfma_f32_16x16x32_bf16 v[112:115], v[140:143], a[164:167], v[104:107]
    ds_read_b64_tr_b16 a[152:153], v18 offset:6208
    ds_read_b64_tr_b16 a[154:155], v18 offset:9280
    v_cvt_pk_bf16_f32 v120, v96, v97
    v_cvt_pk_bf16_f32 v121, v98, v99
    v_cvt_pk_bf16_f32 v68, v84, v85
    v_cvt_pk_bf16_f32 v69, v86, v87
    v_mfma_f32_16x16x32_bf16 v[116:119], v[138:141], a[164:167], v[108:111]
    v_cvt_pk_bf16_f32 v122, v100, v101
    v_cvt_pk_bf16_f32 v123, v102, v103
    v_cvt_pk_bf16_f32 v70, v144, v145
    v_cvt_pk_bf16_f32 v71, v146, v147
    v_mfma_f32_16x16x32_bf16 v[104:107], v[134:137], a[164:167], v[104:107]
    ds_write_b128 v32, v[120:123] offset:13312
    v_cvt_pk_bf16_f32 v212, v88, v89
    v_cvt_pk_bf16_f32 v213, v90, v91
    v_cvt_pk_bf16_f32 v72, v2, v3
    v_cvt_pk_bf16_f32 v73, v4, v5
    v_mfma_f32_16x16x32_bf16 v[108:111], v[132:135], a[164:167], v[108:111]
    ds_read_b128 a[44:47], v33 offset:2048
    v_cvt_pk_bf16_f32 v214, v92, v93
    v_cvt_pk_bf16_f32 v215, v94, v95
    v_cvt_pk_bf16_f32 v74, v6, v7
    v_cvt_pk_bf16_f32 v75, v8, v9
    s_waitcnt lgkmcnt(13)
    v_mfma_f32_16x16x32_bf16 v[88:91], v[128:131], a[132:135], 0
    ds_read_b64_tr_b16 a[156:157], v18 offset:128
    ds_read_b64_tr_b16 a[158:159], v18 offset:12416
    v_mfma_f32_16x16x32_bf16 v[92:95], v[128:131], a[136:139], 0
    ds_read_b64_tr_b16 a[160:161], v18 offset:3200
    ds_read_b64_tr_b16 a[162:163], v18 offset:15488
    s_waitcnt lgkmcnt(15)
    v_mfma_f32_16x16x32_bf16 v[96:99], v[140:143], a[140:143], v[88:91]
    ds_read_b64_tr_b16 a[164:165], v18 offset:6272
    ds_read_b64_tr_b16 a[166:167], v18 offset:9344
    v_cvt_pk_bf16_f32 v124, v112, v113
    v_cvt_pk_bf16_f32 v125, v114, v115
    v_mfma_f32_16x16x32_bf16 v[100:103], v[138:141], a[140:143], v[92:95]
    v_cvt_pk_bf16_f32 v126, v116, v117
    v_cvt_pk_bf16_f32 v127, v118, v119
    v_mfma_f32_16x16x32_bf16 v[88:91], v[134:137], a[140:143], v[88:91]
    ds_write_b128 v32, v[124:127] offset:14336
    v_cvt_pk_bf16_f32 v216, v104, v105
    v_cvt_pk_bf16_f32 v217, v106, v107
    v_mfma_f32_16x16x32_bf16 v[92:95], v[132:135], a[140:143], v[92:95]
    v_cvt_pk_bf16_f32 v218, v108, v109
    v_cvt_pk_bf16_f32 v219, v110, v111
    s_waitcnt lgkmcnt(0)
    s_barrier
    v_mfma_f32_16x16x32_bf16 v[104:107], v[128:131], a[144:147], 0
    ds_read_b64_tr_b16 a[132:133], v18 offset:18432
    ds_read_b64_tr_b16 a[134:135], v18 offset:30720
    v_mfma_f32_16x16x32_bf16 v[108:111], v[128:131], a[148:151], 0
    ds_read_b64_tr_b16 a[136:137], v18 offset:21504
    ds_read_b64_tr_b16 a[138:139], v18 offset:33792
    v_mfma_f32_16x16x32_bf16 v[112:115], v[140:143], a[152:155], v[104:107]
    ds_read_b64_tr_b16 a[140:141], v18 offset:24576
    ds_read_b64_tr_b16 a[142:143], v18 offset:27648
    v_cvt_pk_bf16_f32 v120, v96, v97
    v_cvt_pk_bf16_f32 v121, v98, v99
    v_mfma_f32_16x16x32_bf16 v[116:119], v[138:141], a[152:155], v[108:111]
    ds_read_b128 a[48:51], v33 offset:6144
    v_cvt_pk_bf16_f32 v122, v100, v101
    v_cvt_pk_bf16_f32 v123, v102, v103
    v_mfma_f32_16x16x32_bf16 v[104:107], v[134:137], a[152:155], v[104:107]
    ds_write_b128 v32, v[120:123] offset:0
    ds_read_b128 a[52:55], v33 offset:7168
    v_cvt_pk_bf16_f32 v220, v88, v89
    v_cvt_pk_bf16_f32 v221, v90, v91
    v_mfma_f32_16x16x32_bf16 v[108:111], v[132:135], a[152:155], v[108:111]
    ds_read_b128 a[60:63], v33 offset:12288
    ds_read_b128 a[64:67], v33 offset:13312
    v_cvt_pk_bf16_f32 v222, v92, v93
    v_cvt_pk_bf16_f32 v223, v94, v95
    v_mfma_f32_16x16x32_bf16 v[88:91], v[128:131], a[156:159], 0
    ds_read_b64_tr_b16 a[144:145], v18 offset:18496
    ds_read_b64_tr_b16 a[146:147], v18 offset:30784
    v_mfma_f32_16x16x32_bf16 v[92:95], v[128:131], a[160:163], 0
    ds_read_b64_tr_b16 a[148:149], v18 offset:21568
    ds_read_b64_tr_b16 a[150:151], v18 offset:33856
    v_mfma_f32_16x16x32_bf16 v[96:99], v[140:143], a[164:167], v[88:91]
    ds_read_b64_tr_b16 a[152:153], v18 offset:24640
    ds_read_b64_tr_b16 a[154:155], v18 offset:27712
    v_cvt_pk_bf16_f32 v124, v112, v113
    v_cvt_pk_bf16_f32 v125, v114, v115
    v_mfma_f32_16x16x32_bf16 v[100:103], v[138:141], a[164:167], v[92:95]
    v_cvt_pk_bf16_f32 v126, v116, v117
    v_cvt_pk_bf16_f32 v127, v118, v119
    v_mfma_f32_16x16x32_bf16 v[88:91], v[134:137], a[164:167], v[88:91]
    ds_write_b128 v32, v[124:127] offset:1024
    ds_read_b128 a[56:59], v33 offset:8192
    v_cvt_pk_bf16_f32 v224, v104, v105
    v_cvt_pk_bf16_f32 v225, v106, v107
    v_mfma_f32_16x16x32_bf16 v[92:95], v[132:135], a[164:167], v[92:95]
    ds_read_b128 a[68:71], v33 offset:14336
    v_cvt_pk_bf16_f32 v226, v108, v109
    v_cvt_pk_bf16_f32 v227, v110, v111
    s_waitcnt lgkmcnt(15)
    v_mfma_f32_16x16x32_bf16 v[104:107], v[128:131], a[132:135], 0
    ds_read_b64_tr_b16 a[156:157], v18 offset:18560
    ds_read_b64_tr_b16 a[158:159], v18 offset:30848
    v_mfma_f32_16x16x32_bf16 v[108:111], v[128:131], a[136:139], 0
    ds_read_b64_tr_b16 a[160:161], v18 offset:21632
    ds_read_b64_tr_b16 a[162:163], v18 offset:33920
    s_waitcnt lgkmcnt(15)
    v_mfma_f32_16x16x32_bf16 v[112:115], v[140:143], a[140:143], v[104:107]
    ds_read_b64_tr_b16 a[164:165], v18 offset:24704
    ds_read_b64_tr_b16 a[166:167], v18 offset:27776
    v_cvt_pk_bf16_f32 v120, v96, v97
    v_cvt_pk_bf16_f32 v121, v98, v99
    v_mfma_f32_16x16x32_bf16 v[116:119], v[138:141], a[140:143], v[108:111]
    v_cvt_pk_bf16_f32 v122, v100, v101
    v_cvt_pk_bf16_f32 v123, v102, v103
    v_mfma_f32_16x16x32_bf16 v[104:107], v[134:137], a[140:143], v[104:107]
    ds_write_b128 v32, v[120:123] offset:2048
    v_cvt_pk_bf16_f32 v228, v88, v89
    v_cvt_pk_bf16_f32 v229, v90, v91
    v_mfma_f32_16x16x32_bf16 v[108:111], v[132:135], a[140:143], v[108:111]
    v_cvt_pk_bf16_f32 v230, v92, v93
    v_cvt_pk_bf16_f32 v231, v94, v95
    s_waitcnt lgkmcnt(1)
    s_barrier
    v_mfma_f32_16x16x32_bf16 v[88:91], v[128:131], a[144:147], 0
    ds_read_b64_tr_b16 a[132:133], v18 offset:36864
    ds_read_b64_tr_b16 a[134:135], v18 offset:49152
    v_mfma_f32_16x16x32_bf16 v[92:95], v[128:131], a[148:151], 0
    ds_read_b64_tr_b16 a[136:137], v18 offset:39936
    ds_read_b64_tr_b16 a[138:139], v18 offset:52224
    v_mfma_f32_16x16x32_bf16 v[96:99], v[140:143], a[152:155], v[88:91]
    ds_read_b64_tr_b16 a[140:141], v18 offset:43008
    ds_read_b64_tr_b16 a[142:143], v18 offset:46080
    v_cvt_pk_bf16_f32 v124, v112, v113
    v_cvt_pk_bf16_f32 v125, v114, v115
    v_mfma_f32_16x16x32_bf16 v[100:103], v[138:141], a[152:155], v[92:95]
    v_cvt_pk_bf16_f32 v126, v116, v117
    v_cvt_pk_bf16_f32 v127, v118, v119
    v_mfma_f32_16x16x32_bf16 v[88:91], v[134:137], a[152:155], v[88:91]
    ds_write_b128 v32, v[124:127] offset:6144
    v_cvt_pk_bf16_f32 v232, v104, v105
    v_cvt_pk_bf16_f32 v233, v106, v107
    v_mfma_f32_16x16x32_bf16 v[92:95], v[132:135], a[152:155], v[92:95]
    v_cvt_pk_bf16_f32 v234, v108, v109
    v_cvt_pk_bf16_f32 v235, v110, v111
    v_mfma_f32_16x16x32_bf16 v[104:107], v[128:131], a[156:159], 0
    ds_read_b64_tr_b16 a[144:145], v18 offset:36928
    ds_read_b64_tr_b16 a[146:147], v18 offset:49216
    v_mfma_f32_16x16x32_bf16 v[108:111], v[128:131], a[160:163], 0
    ds_read_b64_tr_b16 a[148:149], v18 offset:40000
    ds_read_b64_tr_b16 a[150:151], v18 offset:52288
    v_mfma_f32_16x16x32_bf16 v[112:115], v[140:143], a[164:167], v[104:107]
    ds_read_b64_tr_b16 a[152:153], v18 offset:43072
    ds_read_b64_tr_b16 a[154:155], v18 offset:46144
    v_cvt_pk_bf16_f32 v120, v96, v97
    v_cvt_pk_bf16_f32 v121, v98, v99
    v_mfma_f32_16x16x32_bf16 v[116:119], v[138:141], a[164:167], v[108:111]
    v_cvt_pk_bf16_f32 v122, v100, v101
    v_cvt_pk_bf16_f32 v123, v102, v103
    v_mfma_f32_16x16x32_bf16 v[104:107], v[134:137], a[164:167], v[104:107]
    ds_write_b128 v32, v[120:123] offset:7168
    v_cvt_pk_bf16_f32 v236, v88, v89
    v_cvt_pk_bf16_f32 v237, v90, v91
    v_mfma_f32_16x16x32_bf16 v[108:111], v[132:135], a[164:167], v[108:111]
    v_cvt_pk_bf16_f32 v238, v92, v93
    v_cvt_pk_bf16_f32 v239, v94, v95
    s_waitcnt lgkmcnt(10)
    v_mfma_f32_16x16x32_bf16 v[88:91], v[128:131], a[132:135], 0
    ds_read_b64_tr_b16 a[156:157], v18 offset:36992
    ds_read_b64_tr_b16 a[158:159], v18 offset:49280
    v_mfma_f32_16x16x32_bf16 v[92:95], v[128:131], a[136:139], 0
    ds_read_b64_tr_b16 a[160:161], v18 offset:40064
    ds_read_b64_tr_b16 a[162:163], v18 offset:52352
    s_waitcnt lgkmcnt(12)
    v_mfma_f32_16x16x32_bf16 v[96:99], v[140:143], a[140:143], v[88:91]
    ds_read_b64_tr_b16 a[164:165], v18 offset:43136
    ds_read_b64_tr_b16 a[166:167], v18 offset:46208
    v_cvt_pk_bf16_f32 v124, v112, v113
    v_cvt_pk_bf16_f32 v125, v114, v115
    v_mfma_f32_16x16x32_bf16 v[100:103], v[138:141], a[140:143], v[92:95]
    v_cvt_pk_bf16_f32 v126, v116, v117
    v_cvt_pk_bf16_f32 v127, v118, v119
    v_mfma_f32_16x16x32_bf16 v[88:91], v[134:137], a[140:143], v[88:91]
    ds_write_b128 v32, v[124:127] offset:8192
    v_cvt_pk_bf16_f32 v240, v104, v105
    v_cvt_pk_bf16_f32 v241, v106, v107
    v_mfma_f32_16x16x32_bf16 v[92:95], v[132:135], a[140:143], v[92:95]
    v_cvt_pk_bf16_f32 v242, v108, v109
    v_cvt_pk_bf16_f32 v243, v110, v111
    s_waitcnt lgkmcnt(10)
    v_mfma_f32_16x16x32_bf16 v[104:107], v[128:131], a[144:147], 0
    v_mfma_f32_16x16x32_bf16 v[108:111], v[128:131], a[148:151], 0
    s_waitcnt lgkmcnt(8)
    v_mfma_f32_16x16x32_bf16 v[112:115], v[140:143], a[152:155], v[104:107]
    v_cvt_pk_bf16_f32 v120, v96, v97
    v_cvt_pk_bf16_f32 v121, v98, v99
    v_mfma_f32_16x16x32_bf16 v[116:119], v[138:141], a[152:155], v[108:111]
    v_cvt_pk_bf16_f32 v122, v100, v101
    v_cvt_pk_bf16_f32 v123, v102, v103
    v_mfma_f32_16x16x32_bf16 v[104:107], v[134:137], a[152:155], v[104:107]
    ds_write_b128 v32, v[120:123] offset:12288
    v_cvt_pk_bf16_f32 v244, v88, v89
    v_cvt_pk_bf16_f32 v245, v90, v91
    v_mfma_f32_16x16x32_bf16 v[108:111], v[132:135], a[152:155], v[108:111]
    v_cvt_pk_bf16_f32 v246, v92, v93
    v_cvt_pk_bf16_f32 v247, v94, v95
    s_waitcnt lgkmcnt(4)
    v_mfma_f32_16x16x32_bf16 v[88:91], v[128:131], a[156:159], 0
    v_mfma_f32_16x16x32_bf16 v[92:95], v[128:131], a[160:163], 0
    s_waitcnt lgkmcnt(2)
    v_mfma_f32_16x16x32_bf16 v[96:99], v[140:143], a[164:167], v[88:91]
    v_cvt_pk_bf16_f32 v124, v112, v113
    v_cvt_pk_bf16_f32 v125, v114, v115
    v_mfma_f32_16x16x32_bf16 v[100:103], v[138:141], a[164:167], v[92:95]
    ds_read_b64_tr_b16 a[120:121], v10 offset:21504
    v_cvt_pk_bf16_f32 v126, v116, v117
    v_cvt_pk_bf16_f32 v127, v118, v119
    v_mfma_f32_16x16x32_bf16 v[88:91], v[134:137], a[164:167], v[88:91]
    ds_write_b128 v32, v[124:127] offset:13312
    ds_read_b64_tr_b16 a[122:123], v12 offset:21504
    v_cvt_pk_bf16_f32 v248, v104, v105
    v_cvt_pk_bf16_f32 v249, v106, v107
    v_mfma_f32_16x16x32_bf16 v[92:95], v[132:135], a[164:167], v[92:95]
    ds_read_b64_tr_b16 a[124:125], v11 offset:21504
    ds_read_b64_tr_b16 a[126:127], v13 offset:21504
    v_cvt_pk_bf16_f32 v250, v108, v109
    v_cvt_pk_bf16_f32 v251, v110, v111
    s_nop 3
    v_cvt_pk_bf16_f32 v120, v96, v97
    v_cvt_pk_bf16_f32 v121, v98, v99
    v_cvt_pk_bf16_f32 v122, v100, v101
    v_cvt_pk_bf16_f32 v123, v102, v103
    ds_write_b128 v32, v[120:123] offset:14336
    v_cvt_pk_bf16_f32 v252, v88, v89
    v_cvt_pk_bf16_f32 v253, v90, v91
    v_cvt_pk_bf16_f32 v254, v92, v93
    v_cvt_pk_bf16_f32 v255, v94, v95
    s_waitcnt lgkmcnt(3)
    .p2align 3
L_ploop:
    s_waitcnt lgkmcnt(3)
    v_mfma_f32_16x16x32_bf16 v[88:91], a[120:123], v[36:39], 0
    ds_read_b64_tr_b16 a[128:129], v10 offset:21568
    v_mfma_f32_16x16x32_bf16 a[108:111], v[148:151], v[40:43], 0
    ds_read_b64_tr_b16 a[130:131], v12 offset:21568
    v_mfma_f32_16x16x32_bf16 a[108:111], v[160:163], v[44:47], a[108:111]
    s_nop 0
    v_mfma_f32_16x16x32_bf16 a[108:111], v[172:175], v[48:51], a[108:111]
    v_mfma_f32_16x16x32_bf16 a[108:111], v[184:187], v[52:55], a[108:111]
    ds_write_b128 v31, a[116:119] offset:16384
    v_mfma_f32_16x16x32_bf16 a[108:111], v[196:199], v[56:59], a[108:111]
    v_mfma_f32_16x16x32_bf16 a[108:111], v[208:211], v[60:63], a[108:111]
    v_mfma_f32_16x16x32_bf16 a[108:111], v[220:223], v[64:67], a[108:111]
    v_cvt_pk_bf16_f32 v76, v88, v89
    v_cvt_pk_bf16_f32 v77, v90, v91
    v_mfma_f32_16x16x32_bf16 a[108:111], v[232:235], v[68:71], a[108:111]
    v_mfma_f32_16x16x32_bf16 a[108:111], v[244:247], v[72:75], a[108:111]
    s_waitcnt vmcnt(0)
    s_waitcnt lgkmcnt(0)
    s_barrier
    v_mfma_f32_16x16x32_bf16 v[92:95], a[124:127], v[36:39], 0
    ds_read_b64_tr_b16 a[120:121], v11 offset:21568
    v_mfma_f32_16x16x32_bf16 a[112:115], v[152:155], v[40:43], 0
    ds_read_b64_tr_b16 a[122:123], v13 offset:21568
    v_mfma_f32_16x16x32_bf16 a[112:115], v[164:167], v[44:47], a[112:115]
    s_nop 0
    v_mfma_f32_16x16x32_bf16 a[112:115], v[176:179], v[48:51], a[112:115]
    ds_read_b128 a[72:75], v33 offset:0
    v_mfma_f32_16x16x32_bf16 a[112:115], v[188:191], v[52:55], a[112:115]
    ds_write_b128 v29, a[108:111] offset:0
    v_mfma_f32_16x16x32_bf16 a[112:115], v[200:203], v[56:59], a[112:115]
    ds_read_b128 a[84:87], v33 offset:6144
    v_mfma_f32_16x16x32_bf16 a[112:115], v[212:215], v[60:63], a[112:115]
    ds_read_b128 a[96:99], v33 offset:12288
    v_mfma_f32_16x16x32_bf16 a[112:115], v[224:227], v[64:67], a[112:115]
    v_cvt_pk_bf16_f32 v78, v92, v93
    v_cvt_pk_bf16_f32 v79, v94, v95
    v_mfma_f32_16x16x32_bf16 a[112:115], v[236:239], v[68:71], a[112:115]
    ds_read_b128 a[76:79], v33 offset:1024
    v_mfma_f32_16x16x32_bf16 a[112:115], v[248:251], v[72:75], a[112:115]
    v_mfma_f32_16x16x32_bf16 v[88:91], a[128:131], v[36:39], 0
    ds_read_b64_tr_b16 a[124:125], v10 offset:21632
    s_mov_b32 s34, s31
    v_mfma_f32_16x16x32_bf16 a[116:119], v[156:159], v[40:43], 0
    ds_read_b64_tr_b16 a[126:127], v12 offset:21632
    s_mov_b32 s31, s32
    v_mfma_f32_16x16x32_bf16 a[116:119], v[168:171], v[44:47], a[116:119]
    s_nop 0
    s_mov_b32 s32, s33
    v_mfma_f32_16x16x32_bf16 a[116:119], v[180:183], v[48:51], a[116:119]
    ds_read_b128 a[88:91], v33 offset:7168
    s_mov_b32 s33, s55
    v_mfma_f32_16x16x32_bf16 a[116:119], v[192:195], v[52:55], a[116:119]
    ds_write_b128 v29, a[112:115] offset:2048
    s_mov_b32 s55, s34
    v_mfma_f32_16x16x32_bf16 a[116:119], v[204:207], v[56:59], a[116:119]
    ds_read_b128 a[100:103], v33 offset:13312
    v_mfma_f32_16x16x32_bf16 a[116:119], v[216:219], v[60:63], a[116:119]
    ds_read_b128 a[80:83], v33 offset:2048
    v_mfma_f32_16x16x32_bf16 a[116:119], v[228:231], v[64:67], a[116:119]
    v_cvt_pk_bf16_f32 v80, v88, v89
    v_cvt_pk_bf16_f32 v81, v90, v91
    v_mfma_f32_16x16x32_bf16 a[116:119], v[240:243], v[68:71], a[116:119]
    ds_read_b128 a[92:95], v33 offset:8192
    v_mfma_f32_16x16x32_bf16 a[116:119], v[252:255], v[72:75], a[116:119]
    s_waitcnt lgkmcnt(12)
    v_mfma_f32_16x16x32_bf16 v[92:95], a[120:123], v[36:39], 0
    ds_read_b64_tr_b16 a[128:129], v11 offset:21632
    v_mfma_f32_16x16x32_bf16 a[108:111], a[0:3], v[40:43], 0
    ds_read_b64_tr_b16 a[130:131], v13 offset:21632
    v_mfma_f32_16x16x32_bf16 a[108:111], a[12:15], v[44:47], a[108:111]
    s_nop 0
    v_add_u32 v10, s31, v14
    v_mfma_f32_16x16x32_bf16 a[108:111], a[24:27], v[48:51], a[108:111]
    ds_read_b128 a[104:107], v33 offset:14336
    v_add_u32 v11, s31, v15
    v_mfma_f32_16x16x32_bf16 a[108:111], a[36:39], v[52:55], a[108:111]
    ds_write_b128 v29, a[116:119] offset:4096
    v_add_u32 v12, s31, v16
    v_mfma_f32_16x16x32_bf16 a[108:111], a[48:51], v[56:59], a[108:111]
    v_add_u32 v13, s31, v17
    v_mfma_f32_16x16x32_bf16 a[108:111], a[60:63], v[60:63], a[108:111]
    v_mfma_f32_16x16x32_bf16 a[108:111], a[72:75], v[64:67], a[108:111]
    v_cvt_pk_bf16_f32 v82, v92, v93
    v_cvt_pk_bf16_f32 v83, v94, v95
    v_mfma_f32_16x16x32_bf16 a[108:111], a[84:87], v[68:71], a[108:111]
    v_mfma_f32_16x16x32_bf16 a[108:111], a[96:99], v[72:75], a[108:111]
    s_waitcnt lgkmcnt(9)
    v_mfma_f32_16x16x32_bf16 v[88:91], a[124:127], v[36:39], 0
    ds_read_b64_tr_b16 a[120:121], v10 offset:0
    v_mfma_f32_16x16x32_bf16 a[112:115], a[4:7], v[40:43], 0
    ds_read_b64_tr_b16 a[122:123], v12 offset:0
    v_mfma_f32_16x16x32_bf16 a[112:115], a[16:19], v[44:47], a[112:115]
    s_nop 0
    v_mfma_f32_16x16x32_bf16 a[112:115], a[28:31], v[48:51], a[112:115]
    v_mfma_f32_16x16x32_bf16 a[112:115], a[40:43], v[52:55], a[112:115]
    ds_write_b128 v31, a[108:111] offset:0
    v_mfma_f32_16x16x32_bf16 a[112:115], a[52:55], v[56:59], a[112:115]
    v_mfma_f32_16x16x32_bf16 a[112:115], a[64:67], v[60:63], a[112:115]
    v_mfma_f32_16x16x32_bf16 a[112:115], a[76:79], v[64:67], a[112:115]
    v_cvt_pk_bf16_f32 v84, v88, v89
    v_cvt_pk_bf16_f32 v85, v90, v91
    v_mfma_f32_16x16x32_bf16 a[112:115], a[88:91], v[68:71], a[112:115]
    v_mfma_f32_16x16x32_bf16 a[112:115], a[100:103], v[72:75], a[112:115]
    s_waitcnt lgkmcnt(5)
    v_mfma_f32_16x16x32_bf16 v[92:95], a[128:131], v[36:39], 0
    ds_read_b64_tr_b16 a[124:125], v11 offset:0
    v_mfma_f32_16x16x32_bf16 a[116:119], a[8:11], v[40:43], 0
    ds_read_b64_tr_b16 a[126:127], v13 offset:0
    v_mfma_f32_16x16x32_bf16 a[116:119], a[20:23], v[44:47], a[116:119]
    s_nop 0
    v_mfma_f32_16x16x32_bf16 a[116:119], a[32:35], v[48:51], a[116:119]
    v_mfma_f32_16x16x32_bf16 a[116:119], a[44:47], v[52:55], a[116:119]
    ds_write_b128 v31, a[112:115] offset:2048
    v_mfma_f32_16x16x32_bf16 a[116:119], a[56:59], v[56:59], a[116:119]
    v_mfma_f32_16x16x32_bf16 a[116:119], a[68:71], v[60:63], a[116:119]
    v_mfma_f32_16x16x32_bf16 a[116:119], a[80:83], v[64:67], a[116:119]
    v_cvt_pk_bf16_f32 v86, v92, v93
    v_cvt_pk_bf16_f32 v87, v94, v95
    v_mfma_f32_16x16x32_bf16 a[116:119], a[92:95], v[68:71], a[116:119]
    v_mfma_f32_16x16x32_bf16 a[116:119], a[104:107], v[72:75], a[116:119]
    s_waitcnt lgkmcnt(4)
    v_mfma_f32_16x16x32_bf16 v[88:91], a[120:123], v[36:39], 0
    ds_read_b64_tr_b16 a[128:129], v10 offset:64
    v_mfma_f32_16x16x32_bf16 a[108:111], v[148:151], v[52:55], 0
    ds_read_b64_tr_b16 a[130:131], v12 offset:64
    v_mfma_f32_16x16x32_bf16 a[108:111], v[160:163], v[56:59], a[108:111]
    s_nop 0
    v_mfma_f32_16x16x32_bf16 a[108:111], v[172:175], v[60:63], a[108:111]
    v_mfma_f32_16x16x32_bf16 a[108:111], v[184:187], v[64:67], a[108:111]
    ds_write_b128 v31, a[116:119] offset:4096
    v_mfma_f32_16x16x32_bf16 a[108:111], v[196:199], v[68:71], a[108:111]
    v_mfma_f32_16x16x32_bf16 a[108:111], v[208:211], v[72:75], a[108:111]
    v_mfma_f32_16x16x32_bf16 a[108:111], v[220:223], v[76:79], a[108:111]
    v_cvt_pk_bf16_f32 v40, v88, v89
    v_cvt_pk_bf16_f32 v41, v90, v91
    v_mfma_f32_16x16x32_bf16 a[108:111], v[232:235], v[80:83], a[108:111]
    v_mfma_f32_16x16x32_bf16 a[108:111], v[244:247], v[84:87], a[108:111]
    s_waitcnt lgkmcnt(0)
    s_barrier
    v_mfma_f32_16x16x32_bf16 v[92:95], a[124:127], v[36:39], 0
    ds_read_b64_tr_b16 a[120:121], v11 offset:64
    v_mfma_f32_16x16x32_bf16 a[112:115], v[152:155], v[52:55], 0
    ds_read_b64_tr_b16 a[122:123], v13 offset:64
    v_mfma_f32_16x16x32_bf16 a[112:115], v[164:167], v[56:59], a[112:115]
    s_nop 0
    v_mfma_f32_16x16x32_bf16 a[112:115], v[176:179], v[60:63], a[112:115]
    v_mfma_f32_16x16x32_bf16 a[112:115], v[188:191], v[64:67], a[112:115]
    ds_write_b128 v29, a[108:111] offset:12288
    v_mfma_f32_16x16x32_bf16 a[112:115], v[200:203], v[68:71], a[112:115]
    v_mfma_f32_16x16x32_bf16 a[112:115], v[212:215], v[72:75], a[112:115]
    v_mfma_f32_16x16x32_bf16 a[112:115], v[224:227], v[76:79], a[112:115]
    v_cvt_pk_bf16_f32 v42, v92, v93
    v_cvt_pk_bf16_f32 v43, v94, v95
    v_mfma_f32_16x16x32_bf16 a[112:115], v[236:239], v[80:83], a[112:115]
    v_mfma_f32_16x16x32_bf16 a[112:115], v[248:251], v[84:87], a[112:115]
    v_mfma_f32_16x16x32_bf16 v[88:91], a[128:131], v[36:39], 0
    ds_read_b64_tr_b16 a[124:125], v10 offset:128
    v_mfma_f32_16x16x32_bf16 a[116:119], v[156:159], v[52:55], 0
    ds_read_b64_tr_b16 a[126:127], v12 offset:128
    v_mfma_f32_16x16x32_bf16 a[116:119], v[168:171], v[56:59], a[116:119]
    s_nop 0
    v_mfma_f32_16x16x32_bf16 a[116:119], v[180:183], v[60:63], a[116:119]
    v_mfma_f32_16x16x32_bf16 a[116:119], v[192:195], v[64:67], a[116:119]
    ds_write_b128 v29, a[112:115] offset:14336
    v_mfma_f32_16x16x32_bf16 a[116:119], v[204:207], v[68:71], a[116:119]
    v_mfma_f32_16x16x32_bf16 a[116:119], v[216:219], v[72:75], a[116:119]
    v_mfma_f32_16x16x32_bf16 a[116:119], v[228:231], v[76:79], a[116:119]
    v_cvt_pk_bf16_f32 v44, v88, v89
    v_cvt_pk_bf16_f32 v45, v90, v91
    v_mfma_f32_16x16x32_bf16 a[116:119], v[240:243], v[80:83], a[116:119]
    v_mfma_f32_16x16x32_bf16 a[116:119], v[252:255], v[84:87], a[116:119]
    s_waitcnt lgkmcnt(4)
    v_mfma_f32_16x16x32_bf16 v[92:95], a[120:123], v[36:39], 0
    ds_read_b64_tr_b16 a[128:129], v11 offset:128
    v_mfma_f32_16x16x32_bf16 a[108:111], a[0:3], v[52:55], 0
    ds_read_b64_tr_b16 a[130:131], v13 offset:128
    v_mfma_f32_16x16x32_bf16 a[108:111], a[12:15], v[56:59], a[108:111]
    s_nop 0
    v_mfma_f32_16x16x32_bf16 a[108:111], a[24:27], v[60:63], a[108:111]
    v_mfma_f32_16x16x32_bf16 a[108:111], a[36:39], v[64:67], a[108:111]
    ds_write_b128 v29, a[116:119] offset:16384
    v_mfma_f32_16x16x32_bf16 a[108:111], a[48:51], v[68:71], a[108:111]
    v_mfma_f32_16x16x32_bf16 a[108:111], a[60:63], v[72:75], a[108:111]
    v_mfma_f32_16x16x32_bf16 a[108:111], a[72:75], v[76:79], a[108:111]
    v_cvt_pk_bf16_f32 v46, v92, v93
    v_cvt_pk_bf16_f32 v47, v94, v95
    v_mfma_f32_16x16x32_bf16 a[108:111], a[84:87], v[80:83], a[108:111]
    v_mfma_f32_16x16x32_bf16 a[108:111], a[96:99], v[84:87], a[108:111]
    s_waitcnt lgkmcnt(4)
    v_mfma_f32_16x16x32_bf16 v[88:91], a[124:127], v[36:39], 0
    ds_read_b64_tr_b16 a[120:121], v10 offset:7168
    v_mfma_f32_16x16x32_bf16 a[112:115], a[4:7], v[52:55], 0
    ds_read_b64_tr_b16 a[122:123], v12 offset:7168
    v_mfma_f32_16x16x32_bf16 a[112:115], a[16:19], v[56:59], a[112:115]
    s_nop 0
    v_mfma_f32_16x16x32_bf16 a[112:115], a[28:31], v[60:63], a[112:115]
    v_mfma_f32_16x16x32_bf16 a[112:115], a[40:43], v[64:67], a[112:115]
    ds_write_b128 v31, a[108:111] offset:12288
    v_mfma_f32_16x16x32_bf16 a[112:115], a[52:55], v[68:71], a[112:115]
    v_mfma_f32_16x16x32_bf16 a[112:115], a[64:67], v[72:75], a[112:115]
    v_mfma_f32_16x16x32_bf16 a[112:115], a[76:79], v[76:79], a[112:115]
    v_cvt_pk_bf16_f32 v48, v88, v89
    v_cvt_pk_bf16_f32 v49, v90, v91
    v_mfma_f32_16x16x32_bf16 a[112:115], a[88:91], v[80:83], a[112:115]
    v_mfma_f32_16x16x32_bf16 a[112:115], a[100:103], v[84:87], a[112:115]
    s_waitcnt lgkmcnt(4)
    v_mfma_f32_16x16x32_bf16 v[92:95], a[128:131], v[36:39], 0
    ds_read_b64_tr_b16 a[124:125], v11 offset:7168
    v_mfma_f32_16x16x32_bf16 a[116:119], a[8:11], v[52:55], 0
    ds_read_b64_tr_b16 a[126:127], v13 offset:7168
    v_mfma_f32_16x16x32_bf16 a[116:119], a[20:23], v[56:59], a[116:119]
    s_nop 0
    v_mfma_f32_16x16x32_bf16 a[116:119], a[32:35], v[60:63], a[116:119]
    v_mfma_f32_16x16x32_bf16 a[116:119], a[44:47], v[64:67], a[116:119]
    ds_write_b128 v31, a[112:115] offset:14336
    v_mfma_f32_16x16x32_bf16 a[116:119], a[56:59], v[68:71], a[116:119]
    v_mfma_f32_16x16x32_bf16 a[116:119], a[68:71], v[72:75], a[116:119]
    v_mfma_f32_16x16x32_bf16 a[116:119], a[80:83], v[76:79], a[116:119]
    v_cvt_pk_bf16_f32 v50, v92, v93
    v_cvt_pk_bf16_f32 v51, v94, v95
    v_mfma_f32_16x16x32_bf16 a[116:119], a[92:95], v[80:83], a[116:119]
    v_mfma_f32_16x16x32_bf16 a[116:119], a[104:107], v[84:87], a[116:119]
    s_waitcnt lgkmcnt(4)
    v_mfma_f32_16x16x32_bf16 v[88:91], a[120:123], v[36:39], 0
    ds_read_b64_tr_b16 a[128:129], v10 offset:7232
    v_mfma_f32_16x16x32_bf16 a[108:111], v[148:151], v[64:67], 0
    ds_read_b64_tr_b16 a[130:131], v12 offset:7232
    v_mfma_f32_16x16x32_bf16 a[108:111], v[160:163], v[68:71], a[108:111]
    s_nop 0
    v_mfma_f32_16x16x32_bf16 a[108:111], v[172:175], v[72:75], a[108:111]
    v_mfma_f32_16x16x32_bf16 a[108:111], v[184:187], v[76:79], a[108:111]
    ds_write_b128 v31, a[116:119] offset:16384
    v_mfma_f32_16x16x32_bf16 a[108:111], v[196:199], v[80:83], a[108:111]
    v_mfma_f32_16x16x32_bf16 a[108:111], v[208:211], v[84:87], a[108:111]
    v_mfma_f32_16x16x32_bf16 a[108:111], v[220:223], v[40:43], a[108:111]
    v_cvt_pk_bf16_f32 v52, v88, v89
    v_cvt_pk_bf16_f32 v53, v90, v91
    v_mfma_f32_16x16x32_bf16 a[108:111], v[232:235], v[44:47], a[108:111]
    v_mfma_f32_16x16x32_bf16 a[108:111], v[244:247], v[48:51], a[108:111]
    s_waitcnt lgkmcnt(0)
    s_barrier
    v_mfma_f32_16x16x32_bf16 v[92:95], a[124:127], v[36:39], 0
    ds_read_b64_tr_b16 a[120:121], v11 offset:7232
    v_mfma_f32_16x16x32_bf16 a[112:115], v[152:155], v[64:67], 0
    ds_read_b64_tr_b16 a[122:123], v13 offset:7232
    v_mfma_f32_16x16x32_bf16 a[112:115], v[164:167], v[68:71], a[112:115]
    s_nop 0
    v_mfma_f32_16x16x32_bf16 a[112:115], v[176:179], v[72:75], a[112:115]
    v_mfma_f32_16x16x32_bf16 a[112:115], v[188:191], v[76:79], a[112:115]
    ds_write_b128 v29, a[108:111] offset:0
    v_mfma_f32_16x16x32_bf16 a[112:115], v[200:203], v[80:83], a[112:115]
    v_mfma_f32_16x16x32_bf16 a[112:115], v[212:215], v[84:87], a[112:115]
    v_mfma_f32_16x16x32_bf16 a[112:115], v[224:227], v[40:43], a[112:115]
    v_cvt_pk_bf16_f32 v54, v92, v93
    v_cvt_pk_bf16_f32 v55, v94, v95
    v_mfma_f32_16x16x32_bf16 a[112:115], v[236:239], v[44:47], a[112:115]
    v_mfma_f32_16x16x32_bf16 a[112:115], v[248:251], v[48:51], a[112:115]
    v_mfma_f32_16x16x32_bf16 v[88:91], a[128:131], v[36:39], 0
    ds_read_b64_tr_b16 a[124:125], v10 offset:7296
    v_mfma_f32_16x16x32_bf16 a[116:119], v[156:159], v[64:67], 0
    ds_read_b64_tr_b16 a[126:127], v12 offset:7296
    v_mfma_f32_16x16x32_bf16 a[116:119], v[168:171], v[68:71], a[116:119]
    s_nop 0
    v_mfma_f32_16x16x32_bf16 a[116:119], v[180:183], v[72:75], a[116:119]
    v_mfma_f32_16x16x32_bf16 a[116:119], v[192:195], v[76:79], a[116:119]
    ds_write_b128 v29, a[112:115] offset:2048
    v_mfma_f32_16x16x32_bf16 a[116:119], v[204:207], v[80:83], a[116:119]
    v_mfma_f32_16x16x32_bf16 a[116:119], v[216:219], v[84:87], a[116:119]
    v_mfma_f32_16x16x32_bf16 a[116:119], v[228:231], v[40:43], a[116:119]
    v_cvt_pk_bf16_f32 v56, v88, v89
    v_cvt_pk_bf16_f32 v57, v90, v91
    v_mfma_f32_16x16x32_bf16 a[116:119], v[240:243], v[44:47], a[116:119]
    v_mfma_f32_16x16x32_bf16 a[116:119], v[252:255], v[48:51], a[116:119]
    s_waitcnt lgkmcnt(4)
    v_mfma_f32_16x16x32_bf16 v[92:95], a[120:123], v[36:39], 0
    ds_read_b64_tr_b16 a[128:129], v11 offset:7296
    v_mfma_f32_16x16x32_bf16 a[108:111], a[0:3], v[64:67], 0
    ds_read_b64_tr_b16 a[130:131], v13 offset:7296
    v_mfma_f32_16x16x32_bf16 a[108:111], a[12:15], v[68:71], a[108:111]
    s_nop 0
    v_mfma_f32_16x16x32_bf16 a[108:111], a[24:27], v[72:75], a[108:111]
    v_mfma_f32_16x16x32_bf16 a[108:111], a[36:39], v[76:79], a[108:111]
    ds_write_b128 v29, a[116:119] offset:4096
    v_mfma_f32_16x16x32_bf16 a[108:111], a[48:51], v[80:83], a[108:111]
    v_mfma_f32_16x16x32_bf16 a[108:111], a[60:63], v[84:87], a[108:111]
    v_mfma_f32_16x16x32_bf16 a[108:111], a[72:75], v[40:43], a[108:111]
    v_cvt_pk_bf16_f32 v58, v92, v93
    v_cvt_pk_bf16_f32 v59, v94, v95
    v_mfma_f32_16x16x32_bf16 a[108:111], a[84:87], v[44:47], a[108:111]
    v_mfma_f32_16x16x32_bf16 a[108:111], a[96:99], v[48:51], a[108:111]
    s_waitcnt lgkmcnt(4)
    v_mfma_f32_16x16x32_bf16 v[88:91], a[124:127], v[36:39], 0
    ds_read_b64_tr_b16 a[120:121], v10 offset:14336
    v_mfma_f32_16x16x32_bf16 a[112:115], a[4:7], v[64:67], 0
    ds_read_b64_tr_b16 a[122:123], v12 offset:14336
    v_mfma_f32_16x16x32_bf16 a[112:115], a[16:19], v[68:71], a[112:115]
    s_nop 0
    v_mfma_f32_16x16x32_bf16 a[112:115], a[28:31], v[72:75], a[112:115]
    v_mfma_f32_16x16x32_bf16 a[112:115], a[40:43], v[76:79], a[112:115]
    ds_write_b128 v31, a[108:111] offset:0
    v_mfma_f32_16x16x32_bf16 a[112:115], a[52:55], v[80:83], a[112:115]
    v_mfma_f32_16x16x32_bf16 a[112:115], a[64:67], v[84:87], a[112:115]
    v_mfma_f32_16x16x32_bf16 a[112:115], a[76:79], v[40:43], a[112:115]
    v_cvt_pk_bf16_f32 v60, v88, v89
    v_cvt_pk_bf16_f32 v61, v90, v91
    v_mfma_f32_16x16x32_bf16 a[112:115], a[88:91], v[44:47], a[112:115]
    v_mfma_f32_16x16x32_bf16 a[112:115], a[100:103], v[48:51], a[112:115]
    s_waitcnt lgkmcnt(4)
    v_mfma_f32_16x16x32_bf16 v[92:95], a[128:131], v[36:39], 0
    ds_read_b64_tr_b16 a[124:125], v11 offset:14336
    v_mfma_f32_16x16x32_bf16 a[116:119], a[8:11], v[64:67], 0
    ds_read_b64_tr_b16 a[126:127], v13 offset:14336
    v_mfma_f32_16x16x32_bf16 a[116:119], a[20:23], v[68:71], a[116:119]
    s_nop 0
    v_mfma_f32_16x16x32_bf16 a[116:119], a[32:35], v[72:75], a[116:119]
    v_mfma_f32_16x16x32_bf16 a[116:119], a[44:47], v[76:79], a[116:119]
    ds_write_b128 v31, a[112:115] offset:2048
    v_mfma_f32_16x16x32_bf16 a[116:119], a[56:59], v[80:83], a[116:119]
    v_mfma_f32_16x16x32_bf16 a[116:119], a[68:71], v[84:87], a[116:119]
    v_mfma_f32_16x16x32_bf16 a[116:119], a[80:83], v[40:43], a[116:119]
    v_cvt_pk_bf16_f32 v62, v92, v93
    v_cvt_pk_bf16_f32 v63, v94, v95
    v_mfma_f32_16x16x32_bf16 a[116:119], a[92:95], v[44:47], a[116:119]
    v_mfma_f32_16x16x32_bf16 a[116:119], a[104:107], v[48:51], a[116:119]
    s_waitcnt lgkmcnt(4)
    v_mfma_f32_16x16x32_bf16 v[88:91], a[120:123], v[36:39], 0
    ds_read_b64_tr_b16 a[128:129], v10 offset:14400
    v_mfma_f32_16x16x32_bf16 a[108:111], v[148:151], v[76:79], 0
    ds_read_b64_tr_b16 a[130:131], v12 offset:14400
    v_mfma_f32_16x16x32_bf16 a[108:111], v[160:163], v[80:83], a[108:111]
    s_nop 0
    v_mfma_f32_16x16x32_bf16 a[108:111], v[172:175], v[84:87], a[108:111]
    v_mfma_f32_16x16x32_bf16 a[108:111], v[184:187], v[40:43], a[108:111]
    ds_write_b128 v31, a[116:119] offset:4096
    v_mfma_f32_16x16x32_bf16 a[108:111], v[196:199], v[44:47], a[108:111]
    v_mfma_f32_16x16x32_bf16 a[108:111], v[208:211], v[48:51], a[108:111]
    v_mfma_f32_16x16x32_bf16 a[108:111], v[220:223], v[52:55], a[108:111]
    v_cvt_pk_bf16_f32 v64, v88, v89
    v_cvt_pk_bf16_f32 v65, v90, v91
    v_mfma_f32_16x16x32_bf16 a[108:111], v[232:235], v[56:59], a[108:111]
    v_mfma_f32_16x16x32_bf16 a[108:111], v[244:247], v[60:63], a[108:111]
    s_waitcnt lgkmcnt(0)
    s_barrier
    v_mfma_f32_16x16x32_bf16 v[92:95], a[124:127], v[36:39], 0
    ds_read_b64_tr_b16 a[120:121], v11 offset:14400
    v_mfma_f32_16x16x32_bf16 a[112:115], v[152:155], v[76:79], 0
    ds_read_b64_tr_b16 a[122:123], v13 offset:14400
    v_mfma_f32_16x16x32_bf16 a[112:115], v[164:167], v[80:83], a[112:115]
    s_nop 0
    v_mfma_f32_16x16x32_bf16 a[112:115], v[176:179], v[84:87], a[112:115]
    v_mfma_f32_16x16x32_bf16 a[112:115], v[188:191], v[40:43], a[112:115]
    ds_write_b128 v29, a[108:111] offset:12288
    v_mfma_f32_16x16x32_bf16 a[112:115], v[200:203], v[44:47], a[112:115]
    v_mfma_f32_16x16x32_bf16 a[112:115], v[212:215], v[48:51], a[112:115]
    v_mfma_f32_16x16x32_bf16 a[112:115], v[224:227], v[52:55], a[112:115]
    v_cvt_pk_bf16_f32 v66, v92, v93
    v_cvt_pk_bf16_f32 v67, v94, v95
    v_mfma_f32_16x16x32_bf16 a[112:115], v[236:239], v[56:59], a[112:115]
    v_mfma_f32_16x16x32_bf16 a[112:115], v[248:251], v[60:63], a[112:115]
    v_mfma_f32_16x16x32_bf16 v[88:91], a[128:131], v[36:39], 0
    ds_read_b64_tr_b16 a[124:125], v10 offset:14464
    s_sub_u32 s30, s30, 1
    v_mfma_f32_16x16x32_bf16 a[116:119], v[156:159], v[76:79], 0
    ds_read_b64_tr_b16 a[126:127], v12 offset:14464
    v_mfma_f32_16x16x32_bf16 a[116:119], v[168:171], v[80:83], a[116:119]
    s_nop 0
    v_mfma_f32_16x16x32_bf16 a[116:119], v[180:183], v[84:87], a[116:119]
    v_mfma_f32_16x16x32_bf16 a[116:119], v[192:195], v[40:43], a[116:119]
    ds_write_b128 v29, a[112:115] offset:14336
    v_mfma_f32_16x16x32_bf16 a[116:119], v[204:207], v[44:47], a[116:119]
    v_mfma_f32_16x16x32_bf16 a[116:119], v[216:219], v[48:51], a[116:119]
    v_mfma_f32_16x16x32_bf16 a[116:119], v[228:231], v[52:55], a[116:119]
    v_cvt_pk_bf16_f32 v68, v88, v89
    v_cvt_pk_bf16_f32 v69, v90, v91
    v_mfma_f32_16x16x32_bf16 a[116:119], v[240:243], v[56:59], a[116:119]
    v_mfma_f32_16x16x32_bf16 a[116:119], v[252:255], v[60:63], a[116:119]
    s_waitcnt lgkmcnt(4)
    v_mfma_f32_16x16x32_bf16 v[92:95], a[120:123], v[36:39], 0
    ds_read_b64_tr_b16 a[128:129], v11 offset:14464
    v_mfma_f32_16x16x32_bf16 a[108:111], a[0:3], v[76:79], 0
    ds_read_b64_tr_b16 a[130:131], v13 offset:14464
    v_mfma_f32_16x16x32_bf16 a[108:111], a[12:15], v[80:83], a[108:111]
    s_nop 0
    v_mfma_f32_16x16x32_bf16 a[108:111], a[24:27], v[84:87], a[108:111]
    v_mfma_f32_16x16x32_bf16 a[108:111], a[36:39], v[40:43], a[108:111]
    ds_write_b128 v29, a[116:119] offset:16384
    v_mfma_f32_16x16x32_bf16 a[108:111], a[48:51], v[44:47], a[108:111]
    v_mfma_f32_16x16x32_bf16 a[108:111], a[60:63], v[48:51], a[108:111]
    v_mfma_f32_16x16x32_bf16 a[108:111], a[72:75], v[52:55], a[108:111]
    v_cvt_pk_bf16_f32 v70, v92, v93
    v_cvt_pk_bf16_f32 v71, v94, v95
    v_mfma_f32_16x16x32_bf16 a[108:111], a[84:87], v[56:59], a[108:111]
    v_mfma_f32_16x16x32_bf16 a[108:111], a[96:99], v[60:63], a[108:111]
    s_waitcnt lgkmcnt(4)
    v_mfma_f32_16x16x32_bf16 v[88:91], a[124:127], v[36:39], 0
    ds_read_b64_tr_b16 a[120:121], v10 offset:21504
    v_mfma_f32_16x16x32_bf16 a[112:115], a[4:7], v[76:79], 0
    ds_read_b64_tr_b16 a[122:123], v12 offset:21504
    v_mfma_f32_16x16x32_bf16 a[112:115], a[16:19], v[80:83], a[112:115]
    s_nop 0
    v_mfma_f32_16x16x32_bf16 a[112:115], a[28:31], v[84:87], a[112:115]
    v_mfma_f32_16x16x32_bf16 a[112:115], a[40:43], v[40:43], a[112:115]
    ds_write_b128 v31, a[108:111] offset:12288
    v_mfma_f32_16x16x32_bf16 a[112:115], a[52:55], v[44:47], a[112:115]
    v_mfma_f32_16x16x32_bf16 a[112:115], a[64:67], v[48:51], a[112:115]
    v_mfma_f32_16x16x32_bf16 a[112:115], a[76:79], v[52:55], a[112:115]
    v_cvt_pk_bf16_f32 v72, v88, v89
    v_cvt_pk_bf16_f32 v73, v90, v91
    v_mfma_f32_16x16x32_bf16 a[112:115], a[88:91], v[56:59], a[112:115]
    v_mfma_f32_16x16x32_bf16 a[112:115], a[100:103], v[60:63], a[112:115]
    s_waitcnt lgkmcnt(4)
    v_mfma_f32_16x16x32_bf16 v[92:95], a[128:131], v[36:39], 0
    ds_read_b64_tr_b16 a[124:125], v11 offset:21504
    v_mfma_f32_16x16x32_bf16 a[116:119], a[8:11], v[76:79], 0
    ds_read_b64_tr_b16 a[126:127], v13 offset:21504
    v_mfma_f32_16x16x32_bf16 a[116:119], a[20:23], v[80:83], a[116:119]
    s_nop 0
    v_mfma_f32_16x16x32_bf16 a[116:119], a[32:35], v[84:87], a[116:119]
    v_mfma_f32_16x16x32_bf16 a[116:119], a[44:47], v[40:43], a[116:119]
    ds_write_b128 v31, a[112:115] offset:14336
    v_mfma_f32_16x16x32_bf16 a[116:119], a[56:59], v[44:47], a[116:119]
    v_mfma_f32_16x16x32_bf16 a[116:119], a[68:71], v[48:51], a[116:119]
    s_cmp_lg_u32 s30, 0
    v_mfma_f32_16x16x32_bf16 a[116:119], a[80:83], v[52:55], a[116:119]
    v_cvt_pk_bf16_f32 v74, v92, v93
    v_cvt_pk_bf16_f32 v75, v94, v95
    v_mfma_f32_16x16x32_bf16 a[116:119], a[92:95], v[56:59], a[116:119]
    v_mfma_f32_16x16x32_bf16 a[116:119], a[104:107], v[60:63], a[116:119]
    s_cbranch_scc1 L_ploop
    s_nop 7
    ds_write_b128 v31, a[116:119] offset:16384
    s_waitcnt lgkmcnt(0)
    s_barrier
    s_barrier
L_end:
    s_endpgm
.section .rodata,"a"
.p2align 6
.amdhsa_kernel standalone__dilated_atrous__vision_kernel
  .amdhsa_next_free_vgpr 512
  .amdhsa_next_free_sgpr 102
  .amdhsa_accum_offset 256
  .amdhsa_group_segment_fixed_size 0
  .amdhsa_kernarg_size 40
  .amdhsa_user_sgpr_count 2
  .amdhsa_user_sgpr_kernarg_segment_ptr 1
  .amdhsa_system_sgpr_workgroup_id_x 1
.end_amdhsa_kernel
```
